```python
import torch

def _softmax(x, axis=-1):
    return torch.softmax(x, dim=axis)
def _gelu(x):
    return torch.nn.functional.gelu(x, approximate="tanh")
def _silu(x):
    return torch.nn.functional.silu(x)
def _sigmoid(x):
    return torch.sigmoid(x)
def _layernorm(x, axis=-1, eps=1e-5):
    m = x.mean(dim=axis, keepdim=True)
    v = x.var(dim=axis, keepdim=True, unbiased=False)
    return (x - m) / torch.sqrt(v + eps)
def _scatter_add(tgt, idx, src, axis=0):
    return tgt.clone().index_add_(axis, idx, src)
def _segment_sum(src, seg, n):
    out = torch.zeros((n,) + src.shape[1:], dtype=src.dtype)
    return out.index_add_(0, seg, src)
def _pad(x, pw):
    flat = tuple(v for pair in reversed(pw) for v in pair)
    return torch.nn.functional.pad(x, flat)

kernel_name = 'standalone__mha_block_cached__sampling'

def setup_inputs():

    _w = (lambda a: (lambda t: t.to(torch.bfloat16) if t.is_floating_point() else t)(torch.as_tensor(a)))
    B, Sq, D = 8, 8, 512
    H, Sk, Dh = 32, 4096, 128
    return {
        "x": _w((lambda *s: torch.randn(*s, dtype=torch.bfloat16) * 0.8)(B, Sq, D)),
        "k_cache": _w((lambda *s: torch.randn(*s, dtype=torch.bfloat16) * 0.8)(B, H, Sk, Dh)),
        "v_cache": _w((lambda *s: torch.randn(*s, dtype=torch.bfloat16) * 0.05)(B, H, Sk, Dh)),
        "wq": _w((lambda *s: torch.randn(*s, dtype=torch.bfloat16) * 0.8)(D, H * Dh) * (D ** -0.5)),
        "wo": _w((lambda *s: torch.randn(*s, dtype=torch.bfloat16) * 0.05)(H * Dh, D) * ((H * Dh) ** -0.5)),
    }

def reference(x, k_cache, v_cache, wq, wo):
    B, Sq, D = x.shape
    H, Dh = 32, 128
    q = (lambda x, *d: x.permute(*d))((x @ wq).reshape(B, Sq, H, Dh), 0, 2, 1, 3)
    scores = torch.einsum("bhqd,bhkd->bhqk", q, k_cache) * (Dh ** -0.5)
    p = _softmax(scores, axis=-1)
    o = torch.einsum("bhqk,bhkd->bhqd", p, v_cache)
    return (lambda x, *d: x.permute(*d))(o, 0, 2, 1, 3).reshape(B, Sq, H * Dh) @ wo
```

```asm
; @launch kernel=standalone__mha_block_cached__sampling_kernel grid=(256,1,1) block=(256,1,1) lds=156672
; @launch kernel=mha_reduce_kernel grid=(128,1,1) block=(512,1,1) lds=0
.amdgcn_target "amdgcn-amd-amdhsa--gfx950"
.text
.globl standalone__mha_block_cached__sampling_kernel
.p2align 8
.type standalone__mha_block_cached__sampling_kernel,@function
standalone__mha_block_cached__sampling_kernel:
    s_cmp_ge_u32 s2, 256
    s_cbranch_scc1 L_main_end
    s_load_dwordx16 s[4:19], s[0:1], 0
    v_and_b32 v1, 63, v0
    v_lshrrev_b32 v8, 6, v0
    v_and_b32 v2, 15, v0
    v_readfirstlane_b32 s3, v8
    v_lshrrev_b32 v3, 4, v1
    v_and_b32 v10, 7, v2
    v_lshlrev_b32 v9, 4, v2
    v_lshl_add_u32 v5, v3, 15, v9
    v_lshlrev_b32 v11, 10, v10
    v_lshl_add_u32 v11, v3, 3, v11
    v_lshl_add_u32 v11, v3, 10, v9
    v_lshl_add_u32 v6, v8, 8, v11
    v_lshl_add_u32 v11, v3, 2, 0
    v_xor_b32 v11, v11, v2
    v_lshlrev_b32 v11, 4, v11
    v_lshl_add_u32 v24, v3, 8, v11
    v_lshl_add_u32 v11, v3, 2, 1
    v_xor_b32 v11, v11, v2
    v_lshlrev_b32 v11, 4, v11
    v_lshl_add_u32 v25, v3, 8, v11
    v_lshl_add_u32 v11, v3, 2, 2
    v_xor_b32 v11, v11, v2
    v_lshlrev_b32 v11, 4, v11
    v_lshl_add_u32 v26, v3, 8, v11
    v_lshl_add_u32 v11, v3, 2, 3
    v_xor_b32 v11, v11, v2
    v_lshlrev_b32 v11, 4, v11
    v_lshl_add_u32 v27, v3, 8, v11
    s_lshr_b32 s60, s2, 5
    s_and_b32 s52, s2, 31
    s_mul_i32 s63, s3, 33792
    s_add_u32 s63, s63, 21504
    s_and_b32 s47, s3, 1
    s_lshl_b32 s47, s47, 13
    s_lshr_b32 s51, s3, 1
    s_lshl_b32 s51, s51, 15
    s_or_b32 s47, s47, s51
    s_bitcmp1_b32 s2, 3
    s_cselect_b32 s51, 0x4000, 0
    s_or_b32 s47, s47, s51
    s_bitcmp1_b32 s2, 0
    s_cselect_b32 s51, 4096, 0
    s_or_b32 s47, s47, s51
    s_xor_b32 s56, s47, 0x4000
    s_mov_b32 s22, 0x100000
    s_mov_b32 s34, 8192
    s_mov_b32 s23, 0x20000
    s_mov_b32 s31, 0x20000
    s_mov_b32 s35, 0x20000
    s_lshl_b32 s51, s52, 8
    s_sub_u32 s30, 0x400000, s51
    s_lshl_b32 s62, s60, 13
    s_lshl_b32 s44, s2, 20
    s_lshr_b32 s45, s2, 12
    s_lshl_b32 s54, s3, 20
    s_getpc_b64 s[88:89]
L_pc:
    s_lshr_b32 s53, s2, 3
    s_lshl_b32 s53, s53, 10
    v_lshl_add_u32 v13, v0, 2, s53
    v_min_u32 v13, L_red_end-L_pc, v13
    global_load_dword v14, v13, s[88:89]
    s_waitcnt lgkmcnt(0)
    s_add_u32 s32, s4, s62
    s_addc_u32 s33, s5, 0
    s_add_u32 s28, s10, s51
    s_addc_u32 s29, s11, 0
    s_add_u32 s53, s60, 0
    s_and_b32 s53, s53, 7
    s_lshl_b32 s53, s53, 17
    s_add_u32 s53, s53, s54
    buffer_load_dwordx4 v[108:111], v5, s[28:31], s53 offen
    s_add_u32 s53, s53, 8192
    buffer_load_dwordx4 v[112:115], v5, s[28:31], s53 offen
    s_add_u32 s53, s53, 8192
    buffer_load_dwordx4 v[116:119], v5, s[28:31], s53 offen
    s_add_u32 s53, s53, 8192
    buffer_load_dwordx4 v[120:123], v5, s[28:31], s53 offen
    s_lshl_b32 s51, s52, 17
    s_add_u32 s36, s12, s51
    s_addc_u32 s37, s13, 0
    s_mov_b32 s38, 0x20000
    s_mov_b32 s39, 0x20000
    v_lshlrev_b32 v12, 4, v1
    s_lshl_b32 s46, s60, 2
    s_add_u32 s46, s46, s3
    s_lshl_b32 s46, s46, 12
    buffer_load_dwordx4 v[188:191], v12, s[36:39], s46 offen offset:0
    buffer_load_dwordx4 v[192:195], v12, s[36:39], s46 offen offset:1024
    buffer_load_dwordx4 v[196:199], v12, s[36:39], s46 offen offset:2048
    buffer_load_dwordx4 v[200:203], v12, s[36:39], s46 offen offset:3072
    s_add_u32 m0, s63, 16384
    s_mov_b32 s53, 0
    buffer_load_dwordx4 v6, s[32:35], s53 offen lds
    s_add_u32 m0, s63, 17408
    s_mov_b32 s53, 4096
    buffer_load_dwordx4 v6, s[32:35], s53 offen lds
    s_add_u32 s20, s6, s44
    s_addc_u32 s21, s7, s45
    s_add_u32 s46, s56, 0
    s_add_u32 m0, s63, 0
    s_nop 0
    buffer_load_dwordx4 v24, s[20:23], s46 offen offset:0 nt lds
    buffer_load_dwordx4 v25, s[20:23], s46 offen offset:1024 nt lds
    buffer_load_dwordx4 v26, s[20:23], s46 offen offset:2048 nt lds
    buffer_load_dwordx4 v27, s[20:23], s46 offen offset:3072 nt lds
    s_xor_b32 s46, s46, 4096
    s_add_u32 m0, s63, 4096
    s_nop 0
    buffer_load_dwordx4 v24, s[20:23], s46 offen offset:0 nt lds
    buffer_load_dwordx4 v25, s[20:23], s46 offen offset:1024 nt lds
    s_add_u32 s24, s8, s44
    s_addc_u32 s25, s9, s45
    s_mov_b32 s26, 0x100000
    s_mov_b32 s27, 0x20000
    s_add_u32 s44, s47, 393216
    s_add_u32 s45, s56, 393216
    v_and_b32 v11, 3, v2
    v_lshrrev_b32 v12, 2, v2
    v_lshl_add_u32 v11, v11, 2, v12
    v_lshlrev_b32 v11, 8, v11
    v_add_u32 v11, s63, v11
    v_add_u32 v12, 0, v3
    v_xor_b32 v12, v12, v2
    v_lshl_add_u32 v28, v12, 4, v11
    v_add_u32 v12, 4, v3
    v_xor_b32 v12, v12, v2
    v_lshl_add_u32 v29, v12, 4, v11
    v_add_u32 v12, 8, v3
    v_xor_b32 v12, v12, v2
    v_lshl_add_u32 v30, v12, 4, v11
    v_add_u32 v12, 12, v3
    v_xor_b32 v12, v12, v2
    v_lshl_add_u32 v31, v12, 4, v11
    v_lshlrev_b32 v4, 4, v1
    v_lshl_add_u32 v7, v3, 11, v9
    v_lshl_add_u32 v7, v8, 8, v7
    s_mov_b32 s48, 0x05040100
    s_mov_b32 s49, 0x07060302
    s_mov_b32 s50, 0x3e0293ee
    v_mul_u32_u24 v11, 272, v10
    v_lshl_add_u32 v15, v3, 4, v11
    v_mul_u32_u24 v11, 528, v10
    v_lshl_add_u32 v11, v3, 7, v11
    v_mul_u32_u24 v12, 4224, v8
    v_add_u32 v22, v11, v12
    s_add_u32 s51, s63, 16384
    v_lshl_add_u32 v11, v3, 3, v10
    v_lshlrev_b32 v11, 4, v11
    v_add_u32 v23, s51, v11
    s_add_u32 s51, s51, 512
    v_lshlrev_b32 v11, 2, v10
    v_add_u32 v6, s51, v11
    s_lshl_b32 s51, s52, 17
    s_add_u32 s36, s12, s51
    s_addc_u32 s37, s13, 0
    s_mov_b32 s38, 0x20000
    s_mov_b32 s39, 0x20000
    s_lshl_b32 s51, s2, 14
    s_add_u32 s40, s18, s51
    s_addc_u32 s41, s19, 0
    s_mov_b32 s42, 0x4000
    s_mov_b32 s43, 0x20000
    s_mov_b32 s55, 0
    s_mov_b32 s84, s16
    s_mov_b32 s85, s17
    s_mov_b32 s86, 256
    s_mov_b32 s87, 0x20000
    s_mov_b32 s58, 1
    s_and_b32 s51, s2, 7
    s_lshl_b32 s51, s51, 5
    s_cmp_eq_u32 s3, 0
    s_cselect_b32 s51, s51, 0x1000
    v_and_b32 v208, 31, v1
    v_add_u32 v208, s51, v208
    s_lshr_b32 s57, s2, 3
    s_add_u32 s51, s51, s57
    v_mov_b32 v204, s51
    v_mov_b32 v209, 1
    s_lshl_b32 s51, s3, 2
    v_mov_b32 v206, s51
    v_mov_b32 v205, 0
    s_mov_b64 vcc, 0
    v_mov_b32 v16, 0xff7fffff
    v_mov_b32 v17, 0
    s_add_u32 s53, s60, 1
    s_and_b32 s53, s53, 7
    s_lshl_b32 s53, s53, 17
    s_add_u32 s53, s53, s54
    buffer_load_dwordx4 v[124:127], v5, s[28:31], s53 offen
    s_add_u32 s53, s53, 8192
    buffer_load_dwordx4 v26, s[20:23], s46 offen offset:2048 nt lds
    buffer_load_dwordx4 v27, s[20:23], s46 offen offset:3072 nt lds
    s_waitcnt vmcnt(8)
    buffer_load_dwordx4 v[128:131], v5, s[28:31], s53 offen
    s_add_u32 s53, s53, 8192
    s_waitcnt vmcnt(8)
    s_add_u32 s46, s56, 65536
    s_add_u32 m0, s63, 8192
    s_nop 0
    buffer_load_dwordx4 v24, s[20:23], s46 offen offset:0 nt lds
    s_waitcnt vmcnt(8)
    buffer_load_dwordx4 v[132:135], v5, s[28:31], s53 offen
    s_add_u32 s53, s53, 8192
    s_waitcnt vmcnt(8)
    buffer_load_dwordx4 v25, s[20:23], s46 offen offset:1024 nt lds
    ds_read_b128 a[0:3], v28 offset:0
    ds_read_b128 a[4:7], v29 offset:0
    ds_read_b128 a[8:11], v30 offset:0
    ds_read_b128 a[12:15], v31 offset:0
    s_waitcnt vmcnt(8)
    buffer_load_dwordx4 v26, s[20:23], s46 offen offset:2048 nt lds
    s_waitcnt vmcnt(8)
    buffer_load_dwordx4 v[136:139], v5, s[28:31], s53 offen
    s_waitcnt vmcnt(8)
    buffer_load_dwordx4 v27, s[20:23], s46 offen offset:3072 nt lds
    s_waitcnt vmcnt(8)
    s_xor_b32 s46, s46, 4096
    s_add_u32 m0, s63, 12288
    s_nop 0
    buffer_load_dwordx4 v24, s[20:23], s46 offen offset:0 nt lds
    s_waitcnt vmcnt(8)
    s_add_u32 s53, s60, 2
    s_and_b32 s53, s53, 7
    s_lshl_b32 s53, s53, 17
    s_add_u32 s53, s53, s54
    buffer_load_dwordx4 v[140:143], v5, s[28:31], s53 offen
    s_add_u32 s53, s53, 8192
    s_waitcnt vmcnt(8)
    buffer_load_dwordx4 v25, s[20:23], s46 offen offset:1024 nt lds
    ds_read_b128 a[16:19], v28 offset:4096
    ds_read_b128 a[20:23], v29 offset:4096
    ds_read_b128 a[24:27], v30 offset:4096
    ds_read_b128 a[28:31], v31 offset:4096
    s_waitcnt vmcnt(8)
    buffer_load_dwordx4 v[144:147], v5, s[28:31], s53 offen
    s_add_u32 s53, s53, 8192
    s_waitcnt vmcnt(8)
    buffer_load_dwordx4 v26, s[20:23], s46 offen offset:2048 nt lds
    s_waitcnt vmcnt(8)
    buffer_load_dwordx4 v27, s[20:23], s46 offen offset:3072 nt lds
    s_waitcnt vmcnt(8)
    buffer_load_dwordx4 v[148:151], v5, s[28:31], s53 offen
    s_add_u32 s53, s53, 8192
    s_waitcnt lgkmcnt(0)
    s_waitcnt vmcnt(8)
    s_add_u32 s46, s56, 131072
    s_add_u32 m0, s63, 0
    s_nop 0
    buffer_load_dwordx4 v24, s[20:23], s46 offen offset:0 nt lds
    s_waitcnt vmcnt(8)
    buffer_load_dwordx4 v[152:155], v5, s[28:31], s53 offen
    s_waitcnt vmcnt(8)
    buffer_load_dwordx4 v25, s[20:23], s46 offen offset:1024 nt lds
    ds_read_b128 a[32:35], v28 offset:8192
    ds_read_b128 a[36:39], v29 offset:8192
    ds_read_b128 a[40:43], v30 offset:8192
    ds_read_b128 a[44:47], v31 offset:8192
    s_waitcnt vmcnt(8)
    buffer_load_dwordx4 v26, s[20:23], s46 offen offset:2048 nt lds
    s_waitcnt vmcnt(8)
    s_add_u32 s53, s60, 3
    s_and_b32 s53, s53, 7
    s_lshl_b32 s53, s53, 17
    s_add_u32 s53, s53, s54
    buffer_load_dwordx4 v[156:159], v5, s[28:31], s53 offen
    s_add_u32 s53, s53, 8192
    s_waitcnt vmcnt(8)
    buffer_load_dwordx4 v27, s[20:23], s46 offen offset:3072 nt lds
    s_waitcnt vmcnt(8)
    s_xor_b32 s46, s46, 4096
    s_add_u32 m0, s63, 4096
    s_nop 0
    buffer_load_dwordx4 v24, s[20:23], s46 offen offset:0 nt lds
    s_waitcnt vmcnt(8)
    buffer_load_dwordx4 v[160:163], v5, s[28:31], s53 offen
    s_add_u32 s53, s53, 8192
    s_waitcnt vmcnt(8)
    buffer_load_dwordx4 v25, s[20:23], s46 offen offset:1024 nt lds
    ds_read_b128 a[48:51], v28 offset:12288
    ds_read_b128 a[52:55], v29 offset:12288
    ds_read_b128 a[56:59], v30 offset:12288
    ds_read_b128 a[60:63], v31 offset:12288
    s_waitcnt vmcnt(8)
    buffer_load_dwordx4 v[164:167], v5, s[28:31], s53 offen
    s_add_u32 s53, s53, 8192
    s_waitcnt vmcnt(8)
    buffer_load_dwordx4 v26, s[20:23], s46 offen offset:2048 nt lds
    s_waitcnt vmcnt(8)
    buffer_load_dwordx4 v27, s[20:23], s46 offen offset:3072 nt lds
    s_waitcnt vmcnt(8)
    buffer_load_dwordx4 v[168:171], v5, s[28:31], s53 offen
    s_waitcnt lgkmcnt(0)
    s_waitcnt vmcnt(8)
    s_add_u32 s46, s56, 196608
    s_add_u32 m0, s63, 8192
    s_nop 0
    buffer_load_dwordx4 v24, s[20:23], s46 offen offset:0 nt lds
    s_waitcnt vmcnt(8)
    buffer_load_dwordx4 v25, s[20:23], s46 offen offset:1024 nt lds
    ds_read_b128 a[64:67], v28 offset:0
    ds_read_b128 a[68:71], v29 offset:0
    ds_read_b128 a[72:75], v30 offset:0
    ds_read_b128 a[76:79], v31 offset:0
    v_and_b32 v11, 7, v2
    v_lshlrev_b32 v11, 8, v11
    v_lshl_add_u32 v11, v3, 3, v11
    s_add_u32 s51, s60, 0
    s_and_b32 s51, s51, 7
    s_lshl_b32 s51, s51, 5
    s_add_u32 s51, s51, s63
    v_add_u32 v12, s51, v11
    ds_read_b64 v[92:93], v12 offset:16384
    s_add_u32 s51, s60, 1
    s_and_b32 s51, s51, 7
    s_lshl_b32 s51, s51, 5
    s_add_u32 s51, s51, s63
    v_add_u32 v12, s51, v11
    ds_read_b64 v[94:95], v12 offset:16384
    s_add_u32 s51, s60, 2
    s_and_b32 s51, s51, 7
    s_lshl_b32 s51, s51, 5
    s_add_u32 s51, s51, s63
    v_add_u32 v12, s51, v11
    ds_read_b64 v[96:97], v12 offset:16384
    s_add_u32 s51, s60, 3
    s_and_b32 s51, s51, 7
    s_lshl_b32 s51, s51, 5
    s_add_u32 s51, s51, s63
    v_add_u32 v12, s51, v11
    ds_read_b64 v[98:99], v12 offset:16384
    s_add_u32 s51, s60, 4
    s_and_b32 s51, s51, 7
    s_lshl_b32 s51, s51, 5
    s_add_u32 s51, s51, s63
    v_add_u32 v12, s51, v11
    ds_read_b64 v[100:101], v12 offset:16384
    s_add_u32 s51, s60, 5
    s_and_b32 s51, s51, 7
    s_lshl_b32 s51, s51, 5
    s_add_u32 s51, s51, s63
    v_add_u32 v12, s51, v11
    ds_read_b64 v[102:103], v12 offset:16384
    s_add_u32 s51, s60, 6
    s_and_b32 s51, s51, 7
    s_lshl_b32 s51, s51, 5
    s_add_u32 s51, s51, s63
    v_add_u32 v12, s51, v11
    ds_read_b64 v[104:105], v12 offset:16384
    s_add_u32 s51, s60, 7
    s_and_b32 s51, s51, 7
    s_lshl_b32 s51, s51, 5
    s_add_u32 s51, s51, s63
    v_add_u32 v12, s51, v11
    ds_read_b64 v[106:107], v12 offset:16384
    s_waitcnt lgkmcnt(0)
    v_perm_b32 v52, v112, v108, s48
    v_perm_b32 v53, v120, v116, s48
    v_perm_b32 v54, v128, v124, s48
    v_perm_b32 v55, v136, v132, s48
    v_perm_b32 v56, v112, v108, s49
    v_perm_b32 v57, v120, v116, s49
    v_perm_b32 v58, v128, v124, s49
    v_perm_b32 v59, v136, v132, s49
    v_mfma_f32_16x16x32_bf16 v[60:63], v[52:55], v[92:95], 0
    v_perm_b32 v52, v113, v109, s48
    v_perm_b32 v53, v121, v117, s48
    v_perm_b32 v54, v129, v125, s48
    v_perm_b32 v55, v137, v133, s48
    v_mfma_f32_16x16x32_bf16 v[64:67], v[56:59], v[92:95], 0
    v_perm_b32 v56, v113, v109, s49
    v_perm_b32 v57, v121, v117, s49
    v_perm_b32 v58, v129, v125, s49
    v_perm_b32 v59, v137, v133, s49
    v_mfma_f32_16x16x32_bf16 v[68:71], v[52:55], v[92:95], 0
    v_perm_b32 v52, v114, v110, s48
    v_perm_b32 v53, v122, v118, s48
    v_perm_b32 v54, v130, v126, s48
    v_perm_b32 v55, v138, v134, s48
    v_mfma_f32_16x16x32_bf16 v[72:75], v[56:59], v[92:95], 0
    v_perm_b32 v56, v114, v110, s49
    v_perm_b32 v57, v122, v118, s49
    v_perm_b32 v58, v130, v126, s49
    v_perm_b32 v59, v138, v134, s49
    v_mfma_f32_16x16x32_bf16 v[76:79], v[52:55], v[92:95], 0
    v_perm_b32 v52, v115, v111, s48
    v_perm_b32 v53, v123, v119, s48
    v_perm_b32 v54, v131, v127, s48
    v_perm_b32 v55, v139, v135, s48
    v_mfma_f32_16x16x32_bf16 v[80:83], v[56:59], v[92:95], 0
    v_perm_b32 v56, v115, v111, s49
    v_perm_b32 v57, v123, v119, s49
    v_perm_b32 v58, v131, v127, s49
    v_perm_b32 v59, v139, v135, s49
    v_mfma_f32_16x16x32_bf16 v[84:87], v[52:55], v[92:95], 0
    s_nop 1
    v_mfma_f32_16x16x32_bf16 v[88:91], v[56:59], v[92:95], 0
    s_waitcnt vmcnt(8)
    s_add_u32 s53, s60, 4
    s_and_b32 s53, s53, 7
    s_lshl_b32 s53, s53, 17
    s_add_u32 s53, s53, s54
    buffer_load_dwordx4 v[108:111], v5, s[28:31], s53 offen
    s_add_u32 s53, s53, 8192
    s_waitcnt vmcnt(8)
    buffer_load_dwordx4 v26, s[20:23], s46 offen offset:2048 nt lds
    s_waitcnt vmcnt(8)
    buffer_load_dwordx4 v[112:115], v5, s[28:31], s53 offen
    s_add_u32 s53, s53, 8192
    s_waitcnt vmcnt(8)
    buffer_load_dwordx4 v27, s[20:23], s46 offen offset:3072 nt lds
    s_waitcnt vmcnt(8)
    s_xor_b32 s46, s46, 4096
    s_add_u32 m0, s63, 12288
    s_nop 0
    buffer_load_dwordx4 v24, s[20:23], s46 offen offset:0 nt lds
    s_waitcnt vmcnt(8)
    buffer_load_dwordx4 v[116:119], v5, s[28:31], s53 offen
    s_add_u32 s53, s53, 8192
    s_waitcnt vmcnt(8)
    buffer_load_dwordx4 v25, s[20:23], s46 offen offset:1024 nt lds
    ds_read_b128 a[80:83], v28 offset:4096
    ds_read_b128 a[84:87], v29 offset:4096
    ds_read_b128 a[88:91], v30 offset:4096
    ds_read_b128 a[92:95], v31 offset:4096
    s_waitcnt vmcnt(8)
    buffer_load_dwordx4 v[120:123], v5, s[28:31], s53 offen
    s_waitcnt vmcnt(8)
    buffer_load_dwordx4 v26, s[20:23], s46 offen offset:2048 nt lds
    s_waitcnt vmcnt(8)
    buffer_load_dwordx4 v27, s[20:23], s46 offen offset:3072 nt lds
    s_waitcnt vmcnt(8)
    s_add_u32 s53, s60, 5
    s_and_b32 s53, s53, 7
    s_lshl_b32 s53, s53, 17
    s_add_u32 s53, s53, s54
    buffer_load_dwordx4 v[124:127], v5, s[28:31], s53 offen
    s_add_u32 s53, s53, 8192
    s_waitcnt vmcnt(8)
    s_add_u32 s46, s56, 262144
    s_add_u32 m0, s63, 0
    s_nop 0
    buffer_load_dwordx4 v24, s[20:23], s46 offen offset:0 nt lds
    s_waitcnt vmcnt(8)
    buffer_load_dwordx4 v25, s[20:23], s46 offen offset:1024 nt lds
    ds_read_b128 a[96:99], v28 offset:8192
    ds_read_b128 a[100:103], v29 offset:8192
    ds_read_b128 a[104:107], v30 offset:8192
    ds_read_b128 a[108:111], v31 offset:8192
    s_waitcnt vmcnt(8)
    buffer_load_dwordx4 v[128:131], v5, s[28:31], s53 offen
    s_add_u32 s53, s53, 8192
    s_waitcnt vmcnt(8)
    buffer_load_dwordx4 v26, s[20:23], s46 offen offset:2048 nt lds
    s_waitcnt vmcnt(8)
    buffer_load_dwordx4 v[132:135], v5, s[28:31], s53 offen
    s_add_u32 s53, s53, 8192
    s_waitcnt vmcnt(8)
    buffer_load_dwordx4 v27, s[20:23], s46 offen offset:3072 nt lds
    s_waitcnt lgkmcnt(0)
    s_waitcnt vmcnt(8)
    s_xor_b32 s46, s46, 4096
    s_add_u32 m0, s63, 4096
    s_nop 0
    buffer_load_dwordx4 v24, s[20:23], s46 offen offset:0 nt lds
    s_waitcnt vmcnt(8)
    buffer_load_dwordx4 v[136:139], v5, s[28:31], s53 offen
    s_waitcnt vmcnt(8)
    buffer_load_dwordx4 v25, s[20:23], s46 offen offset:1024 nt lds
    ds_read_b128 a[112:115], v28 offset:12288
    ds_read_b128 a[116:119], v29 offset:12288
    ds_read_b128 a[120:123], v30 offset:12288
    ds_read_b128 a[124:127], v31 offset:12288
    s_waitcnt vmcnt(8)
    buffer_load_dwordx4 v26, s[20:23], s46 offen offset:2048 nt lds
    v_perm_b32 v52, v144, v140, s48
    v_perm_b32 v53, v152, v148, s48
    v_perm_b32 v54, v160, v156, s48
    v_perm_b32 v55, v168, v164, s48
    v_perm_b32 v56, v144, v140, s49
    v_perm_b32 v57, v152, v148, s49
    v_perm_b32 v58, v160, v156, s49
    v_perm_b32 v59, v168, v164, s49
    v_mfma_f32_16x16x32_bf16 v[60:63], v[52:55], v[96:99], v[60:63]
    v_perm_b32 v52, v145, v141, s48
    v_perm_b32 v53, v153, v149, s48
    v_perm_b32 v54, v161, v157, s48
    v_perm_b32 v55, v169, v165, s48
    v_mfma_f32_16x16x32_bf16 v[64:67], v[56:59], v[96:99], v[64:67]
    v_perm_b32 v56, v145, v141, s49
    v_perm_b32 v57, v153, v149, s49
    v_perm_b32 v58, v161, v157, s49
    v_perm_b32 v59, v169, v165, s49
    v_mfma_f32_16x16x32_bf16 v[68:71], v[52:55], v[96:99], v[68:71]
    v_perm_b32 v52, v146, v142, s48
    v_perm_b32 v53, v154, v150, s48
    v_perm_b32 v54, v162, v158, s48
    v_perm_b32 v55, v170, v166, s48
    v_mfma_f32_16x16x32_bf16 v[72:75], v[56:59], v[96:99], v[72:75]
    v_perm_b32 v56, v146, v142, s49
    v_perm_b32 v57, v154, v150, s49
    v_perm_b32 v58, v162, v158, s49
    v_perm_b32 v59, v170, v166, s49
    v_mfma_f32_16x16x32_bf16 v[76:79], v[52:55], v[96:99], v[76:79]
    v_perm_b32 v52, v147, v143, s48
    v_perm_b32 v53, v155, v151, s48
    v_perm_b32 v54, v163, v159, s48
    v_perm_b32 v55, v171, v167, s48
    v_mfma_f32_16x16x32_bf16 v[80:83], v[56:59], v[96:99], v[80:83]
    v_perm_b32 v56, v147, v143, s49
    v_perm_b32 v57, v155, v151, s49
    v_perm_b32 v58, v163, v159, s49
    v_perm_b32 v59, v171, v167, s49
    v_mfma_f32_16x16x32_bf16 v[84:87], v[52:55], v[96:99], v[84:87]
    s_nop 1
    v_mfma_f32_16x16x32_bf16 v[88:91], v[56:59], v[96:99], v[88:91]
    s_waitcnt vmcnt(8)
    s_add_u32 s53, s60, 6
    s_and_b32 s53, s53, 7
    s_lshl_b32 s53, s53, 17
    s_add_u32 s53, s53, s54
    buffer_load_dwordx4 v[140:143], v5, s[28:31], s53 offen
    s_add_u32 s53, s53, 8192
    s_waitcnt vmcnt(8)
    buffer_load_dwordx4 v27, s[20:23], s46 offen offset:3072 nt lds
    s_waitcnt vmcnt(8)
    buffer_load_dwordx4 v[144:147], v5, s[28:31], s53 offen
    s_add_u32 s53, s53, 8192
    s_waitcnt vmcnt(8)
    s_add_u32 s46, s56, 327680
    s_add_u32 m0, s63, 8192
    s_nop 0
    buffer_load_dwordx4 v24, s[20:23], s46 offen offset:0 nt lds
    s_waitcnt vmcnt(8)
    buffer_load_dwordx4 v25, s[20:23], s46 offen offset:1024 nt lds
    ds_read_b128 a[128:131], v28 offset:0
    ds_read_b128 a[132:135], v29 offset:0
    ds_read_b128 a[136:139], v30 offset:0
    ds_read_b128 a[140:143], v31 offset:0
    s_waitcnt vmcnt(8)
    buffer_load_dwordx4 v[148:151], v5, s[28:31], s53 offen
    s_add_u32 s53, s53, 8192
    s_waitcnt vmcnt(8)
    buffer_load_dwordx4 v26, s[20:23], s46 offen offset:2048 nt lds
    s_waitcnt vmcnt(8)
    buffer_load_dwordx4 v[152:155], v5, s[28:31], s53 offen
    s_waitcnt vmcnt(8)
    buffer_load_dwordx4 v27, s[20:23], s46 offen offset:3072 nt lds
    s_waitcnt lgkmcnt(0)
    s_waitcnt vmcnt(8)
    s_xor_b32 s46, s46, 4096
    s_add_u32 m0, s63, 12288
    s_nop 0
    buffer_load_dwordx4 v24, s[20:23], s46 offen offset:0 nt lds
    s_waitcnt vmcnt(8)
    s_add_u32 s53, s60, 7
    s_and_b32 s53, s53, 7
    s_lshl_b32 s53, s53, 17
    s_add_u32 s53, s53, s54
    buffer_load_dwordx4 v[156:159], v5, s[28:31], s53 offen
    s_add_u32 s53, s53, 8192
    s_waitcnt vmcnt(8)
    buffer_load_dwordx4 v25, s[20:23], s46 offen offset:1024 nt lds
    ds_read_b128 a[144:147], v28 offset:4096
    ds_read_b128 a[148:151], v29 offset:4096
    ds_read_b128 a[152:155], v30 offset:4096
    ds_read_b128 a[156:159], v31 offset:4096
    s_waitcnt vmcnt(8)
    buffer_load_dwordx4 v26, s[20:23], s46 offen offset:2048 nt lds
    s_waitcnt vmcnt(8)
    buffer_load_dwordx4 v[160:163], v5, s[28:31], s53 offen
    s_add_u32 s53, s53, 8192
    s_waitcnt vmcnt(8)
    buffer_load_dwordx4 v27, s[20:23], s46 offen offset:3072 nt lds
    s_waitcnt vmcnt(8)
    buffer_load_dwordx4 v[164:167], v5, s[28:31], s53 offen
    s_add_u32 s53, s53, 8192
    s_waitcnt vmcnt(8)
    s_add_u32 s46, s47, 0
    s_add_u32 m0, s63, 0
    s_nop 0
    buffer_load_dwordx4 v24, s[20:23], s46 offen offset:0 nt lds
    s_waitcnt vmcnt(8)
    buffer_load_dwordx4 v25, s[20:23], s46 offen offset:1024 nt lds
    ds_read_b128 a[160:163], v28 offset:8192
    ds_read_b128 a[164:167], v29 offset:8192
    ds_read_b128 a[168:171], v30 offset:8192
    ds_read_b128 a[172:175], v31 offset:8192
    s_waitcnt vmcnt(8)
    buffer_load_dwordx4 v[168:171], v5, s[28:31], s53 offen
    s_waitcnt vmcnt(8)
    buffer_load_dwordx4 v26, s[20:23], s46 offen offset:2048 nt lds
    s_waitcnt vmcnt(8)
    buffer_load_dwordx4 v27, s[20:23], s46 offen offset:3072 nt lds
    v_perm_b32 v52, v112, v108, s48
    v_perm_b32 v53, v120, v116, s48
    v_perm_b32 v54, v128, v124, s48
    v_perm_b32 v55, v136, v132, s48
    v_perm_b32 v56, v112, v108, s49
    v_perm_b32 v57, v120, v116, s49
    v_perm_b32 v58, v128, v124, s49
    v_perm_b32 v59, v136, v132, s49
    v_mfma_f32_16x16x32_bf16 v[60:63], v[52:55], v[100:103], v[60:63]
    v_perm_b32 v52, v113, v109, s48
    v_perm_b32 v53, v121, v117, s48
    v_perm_b32 v54, v129, v125, s48
    v_perm_b32 v55, v137, v133, s48
    v_mfma_f32_16x16x32_bf16 v[64:67], v[56:59], v[100:103], v[64:67]
    v_perm_b32 v56, v113, v109, s49
    v_perm_b32 v57, v121, v117, s49
    v_perm_b32 v58, v129, v125, s49
    v_perm_b32 v59, v137, v133, s49
    v_mfma_f32_16x16x32_bf16 v[68:71], v[52:55], v[100:103], v[68:71]
    v_perm_b32 v52, v114, v110, s48
    v_perm_b32 v53, v122, v118, s48
    v_perm_b32 v54, v130, v126, s48
    v_perm_b32 v55, v138, v134, s48
    v_mfma_f32_16x16x32_bf16 v[72:75], v[56:59], v[100:103], v[72:75]
    v_perm_b32 v56, v114, v110, s49
    v_perm_b32 v57, v122, v118, s49
    v_perm_b32 v58, v130, v126, s49
    v_perm_b32 v59, v138, v134, s49
    v_mfma_f32_16x16x32_bf16 v[76:79], v[52:55], v[100:103], v[76:79]
    v_perm_b32 v52, v115, v111, s48
    v_perm_b32 v53, v123, v119, s48
    v_perm_b32 v54, v131, v127, s48
    v_perm_b32 v55, v139, v135, s48
    v_mfma_f32_16x16x32_bf16 v[80:83], v[56:59], v[100:103], v[80:83]
    v_perm_b32 v56, v115, v111, s49
    v_perm_b32 v57, v123, v119, s49
    v_perm_b32 v58, v131, v127, s49
    v_perm_b32 v59, v139, v135, s49
    v_mfma_f32_16x16x32_bf16 v[84:87], v[52:55], v[100:103], v[84:87]
    s_nop 1
    v_mfma_f32_16x16x32_bf16 v[88:91], v[56:59], v[100:103], v[88:91]
    s_waitcnt lgkmcnt(0)
    s_waitcnt vmcnt(8)
    s_xor_b32 s46, s46, 4096
    s_add_u32 m0, s63, 4096
    s_nop 0
    buffer_load_dwordx4 v24, s[20:23], s46 offen offset:0 nt lds
    s_waitcnt vmcnt(8)
    buffer_load_dwordx4 v25, s[20:23], s46 offen offset:1024 nt lds
    s_waitcnt vmcnt(8)
    buffer_load_dwordx4 v26, s[20:23], s46 offen offset:2048 nt lds
    ds_read_b128 a[176:179], v28 offset:12288
    ds_read_b128 a[180:183], v29 offset:12288
    ds_read_b128 a[184:187], v30 offset:12288
    ds_read_b128 a[188:191], v31 offset:12288
    s_waitcnt vmcnt(5)
    v_perm_b32 v52, v144, v140, s48
    v_perm_b32 v53, v152, v148, s48
    v_perm_b32 v54, v160, v156, s48
    v_perm_b32 v55, v168, v164, s48
    v_perm_b32 v56, v144, v140, s49
    v_perm_b32 v57, v152, v148, s49
    v_perm_b32 v58, v160, v156, s49
    v_perm_b32 v59, v168, v164, s49
    v_mfma_f32_16x16x32_bf16 v[60:63], v[52:55], v[104:107], v[60:63]
    v_perm_b32 v52, v145, v141, s48
    v_perm_b32 v53, v153, v149, s48
    v_perm_b32 v54, v161, v157, s48
    v_perm_b32 v55, v169, v165, s48
    v_mfma_f32_16x16x32_bf16 v[64:67], v[56:59], v[104:107], v[64:67]
    v_perm_b32 v56, v145, v141, s49
    v_perm_b32 v57, v153, v149, s49
    v_perm_b32 v58, v161, v157, s49
    v_perm_b32 v59, v169, v165, s49
    v_mfma_f32_16x16x32_bf16 v[68:71], v[52:55], v[104:107], v[68:71]
    v_perm_b32 v52, v146, v142, s48
    v_perm_b32 v53, v154, v150, s48
    v_perm_b32 v54, v162, v158, s48
    v_perm_b32 v55, v170, v166, s48
    v_mfma_f32_16x16x32_bf16 v[72:75], v[56:59], v[104:107], v[72:75]
    v_perm_b32 v56, v146, v142, s49
    v_perm_b32 v57, v154, v150, s49
    v_perm_b32 v58, v162, v158, s49
    v_perm_b32 v59, v170, v166, s49
    v_mfma_f32_16x16x32_bf16 v[76:79], v[52:55], v[104:107], v[76:79]
    v_perm_b32 v52, v147, v143, s48
    v_perm_b32 v53, v155, v151, s48
    v_perm_b32 v54, v163, v159, s48
    v_perm_b32 v55, v171, v167, s48
    v_mfma_f32_16x16x32_bf16 v[80:83], v[56:59], v[104:107], v[80:83]
    v_perm_b32 v56, v147, v143, s49
    v_perm_b32 v57, v155, v151, s49
    v_perm_b32 v58, v163, v159, s49
    v_perm_b32 v59, v171, v167, s49
    v_mfma_f32_16x16x32_bf16 v[84:87], v[52:55], v[104:107], v[84:87]
    s_nop 1
    v_mfma_f32_16x16x32_bf16 v[88:91], v[56:59], v[104:107], v[88:91]
    buffer_load_dwordx4 v27, s[20:23], s46 offen offset:3072 nt lds
    s_add_u32 s46, s47, 65536
    s_add_u32 m0, s63, 8192
    s_nop 0
    buffer_load_dwordx4 v24, s[20:23], s46 offen offset:0 nt lds
    buffer_load_dwordx4 v25, s[20:23], s46 offen offset:1024 nt lds
    v_lshlrev_b32 v5, 4, v1
    v_add_u32 v5, s63, v5
    s_nop 5
    ds_write_b128 v22, v[60:63] offset:0
    ds_write_b128 v22, v[64:67] offset:16
    ds_write_b128 v22, v[68:71] offset:32
    ds_write_b128 v22, v[72:75] offset:48
    ds_write_b128 v22, v[76:79] offset:64
    ds_write_b128 v22, v[80:83] offset:80
    ds_write_b128 v22, v[84:87] offset:96
    ds_write_b128 v22, v[88:91] offset:112
    v_lshrrev_b32 v8, 5, v0
    v_and_b32 v9, 31, v0
    v_mul_u32_u24 v10, 528, v8
    v_lshl_add_u32 v10, v9, 4, v10
    v_mul_u32_u24 v11, 272, v8
    v_lshrrev_b32 v12, 3, v9
    v_lshl_add_u32 v11, v12, 6, v11
    v_and_b32 v12, 7, v9
    v_lshl_add_u32 v11, v12, 1, v11
    s_waitcnt lgkmcnt(0)
    s_barrier
    ds_read_b128 v[32:35], v10 offset:0
    ds_read_b128 v[36:39], v10 offset:4224
    ds_read_b128 v[40:43], v10 offset:8448
    ds_read_b128 v[44:47], v10 offset:12672
    buffer_load_dwordx4 v26, s[20:23], s46 offen offset:2048 nt lds
    buffer_load_dwordx4 v27, s[20:23], s46 offen offset:3072 nt lds
    s_xor_b32 s46, s46, 4096
    s_add_u32 m0, s63, 12288
    s_nop 0
    buffer_load_dwordx4 v24, s[20:23], s46 offen offset:0 nt lds
    s_waitcnt lgkmcnt(0)
    v_add_f32 v32, v32, v36
    v_add_f32 v40, v40, v44
    v_add_f32 v33, v33, v37
    v_add_f32 v41, v41, v45
    v_add_f32 v34, v34, v38
    v_add_f32 v42, v42, v46
    v_add_f32 v35, v35, v39
    v_add_f32 v43, v43, v47
    v_add_f32 v32, v32, v40
    v_add_f32 v33, v33, v41
    v_add_f32 v34, v34, v42
    v_add_f32 v35, v35, v43
    v_cvt_pk_bf16_f32 v48, v32, v33
    v_cvt_pk_bf16_f32 v49, v34, v35
    ds_write_b16 v11, v48 offset:16896
    ds_write_b16_d16_hi v11, v48 offset:16912
    ds_write_b16 v11, v49 offset:16928
    ds_write_b16_d16_hi v11, v49 offset:16944
    s_waitcnt lgkmcnt(0)
    s_barrier
    ds_read_b128 a[192:195], v15 offset:16896
    ds_read_b128 a[196:199], v15 offset:16960
    ds_read_b128 a[200:203], v15 offset:17024
    ds_read_b128 a[204:207], v15 offset:17088
    buffer_load_dwordx4 v25, s[20:23], s46 offen offset:1024 nt lds
    buffer_load_dwordx4 v26, s[20:23], s46 offen offset:2048 nt lds
    buffer_load_dwordx4 v27, s[20:23], s46 offen offset:3072 nt lds
    v_mov_b32 v60, 0
    v_mov_b32 v61, 0
    v_mov_b32 v62, 0
    v_mov_b32 v63, 0
    v_mov_b32 v64, 0
    v_mov_b32 v65, 0
    v_mov_b32 v66, 0
    v_mov_b32 v67, 0
    v_mov_b32 v68, 0
    v_mov_b32 v69, 0
    v_mov_b32 v70, 0
    v_mov_b32 v71, 0
    v_mov_b32 v72, 0
    v_mov_b32 v73, 0
    v_mov_b32 v74, 0
    v_mov_b32 v75, 0
    v_mov_b32 v76, 0
    v_mov_b32 v77, 0
    v_mov_b32 v78, 0
    v_mov_b32 v79, 0
    v_mov_b32 v80, 0
    v_mov_b32 v81, 0
    v_mov_b32 v82, 0
    v_mov_b32 v83, 0
    v_mov_b32 v84, 0
    v_mov_b32 v85, 0
    v_mov_b32 v86, 0
    v_mov_b32 v87, 0
    v_mov_b32 v88, 0
    v_mov_b32 v89, 0
    v_mov_b32 v90, 0
    v_mov_b32 v91, 0
    s_waitcnt vmcnt(12)
    ds_read_b128 a[208:211], v28 offset:0
    ds_read_b128 a[212:215], v29 offset:0
    ds_read_b128 a[216:219], v30 offset:0
    ds_read_b128 a[220:223], v31 offset:0
    s_waitcnt lgkmcnt(0)
    v_mfma_f32_16x16x32_bf16 v[32:35], a[208:211], a[192:195], 0
    v_mfma_f32_16x16x32_bf16 v[32:35], a[212:215], a[196:199], v[32:35]
    v_mfma_f32_16x16x32_bf16 v[32:35], a[216:219], a[200:203], v[32:35]
    v_mfma_f32_16x16x32_bf16 v[32:35], a[220:223], a[204:207], v[32:35]
    s_waitcnt vmcnt(8)
    ds_read_b128 a[208:211], v28 offset:4096
    ds_read_b128 a[212:215], v29 offset:4096
    ds_read_b128 a[216:219], v30 offset:4096
    ds_read_b128 a[220:223], v31 offset:4096
    s_waitcnt vmcnt(4)
    s_add_u32 s46, s47, 131072
    s_add_u32 m0, s63, 0
    s_nop 0
    buffer_load_dwordx4 v24, s[20:23], s46 offen offset:0 nt lds
    s_waitcnt lgkmcnt(0)
    v_mfma_f32_16x16x32_bf16 v[36:39], a[208:211], a[192:195], 0
    v_mfma_f32_16x16x32_bf16 v[36:39], a[212:215], a[196:199], v[36:39]
    v_mfma_f32_16x16x32_bf16 v[36:39], a[216:219], a[200:203], v[36:39]
    v_mfma_f32_16x16x32_bf16 v[36:39], a[220:223], a[204:207], v[36:39]
    s_waitcnt vmcnt(4)
    buffer_load_dwordx4 v25, s[20:23], s46 offen offset:1024 nt lds
    s_nop 7
    v_max3_f32 v19, v32, v33, v34
    v_max3_f32 v20, v35, v36, v37
    v_max3_f32 v19, v19, v38, v39
    v_max_f32 v19, v19, v20
    v_mov_b32 v20, v19
    s_nop 1
    v_permlane32_swap_b32 v19, v20
    v_max_f32 v19, v19, v20
    v_mov_b32 v20, v19
    s_nop 1
    v_permlane16_swap_b32 v19, v20
    v_max_f32 v19, v19, v20
    v_mul_f32 v19, s50, v19
    v_max_f32 v19, v19, v16
    v_sub_f32 v18, v16, v19
    v_mov_b32 v16, v19
    v_exp_f32 v18, v18
    v_fma_f32 v32, v32, s50, -v19
    v_fma_f32 v33, v33, s50, -v19
    v_fma_f32 v34, v34, s50, -v19
    v_fma_f32 v35, v35, s50, -v19
    v_fma_f32 v36, v36, s50, -v19
    v_fma_f32 v37, v37, s50, -v19
    v_fma_f32 v38, v38, s50, -v19
    v_fma_f32 v39, v39, s50, -v19
    s_waitcnt vmcnt(4)
    buffer_load_dwordx4 v26, s[20:23], s46 offen offset:2048 nt lds
    v_exp_f32 v32, v32
    v_exp_f32 v33, v33
    v_exp_f32 v34, v34
    v_exp_f32 v35, v35
    v_exp_f32 v36, v36
    v_exp_f32 v37, v37
    v_exp_f32 v38, v38
    v_exp_f32 v39, v39
    v_mul_f32 v17, v17, v18
    v_cvt_pk_bf16_f32 v48, v32, v33
    v_cvt_pk_bf16_f32 v49, v34, v35
    v_cvt_pk_bf16_f32 v50, v36, v37
    v_cvt_pk_bf16_f32 v51, v38, v39
    ds_write_b32 v6, v18
    ds_write_b128 v23, v[48:51]
    v_add_f32 v19, v32, v33
    v_add_f32 v20, v34, v35
    v_add_f32 v21, v36, v37
    v_add_f32 v19, v19, v20
    v_add_f32 v20, v38, v39
    v_add_f32 v21, v21, v20
    v_add_f32 v19, v19, v21
    v_add_f32 v17, v17, v19
    v_add_u32 v6, 544, v6
    v_add_u32 v23, 544, v23
    s_waitcnt vmcnt(4)
    buffer_load_dwordx4 v27, s[20:23], s46 offen offset:3072 nt lds
    ds_read_b128 a[208:211], v28 offset:8192
    ds_read_b128 a[212:215], v29 offset:8192
    ds_read_b128 a[216:219], v30 offset:8192
    ds_read_b128 a[220:223], v31 offset:8192
    s_waitcnt vmcnt(4)
    s_xor_b32 s46, s46, 4096
    s_add_u32 m0, s63, 4096
    s_nop 0
    buffer_load_dwordx4 v24, s[20:23], s46 offen offset:0 nt lds
    s_waitcnt lgkmcnt(0)
    v_mfma_f32_16x16x32_bf16 v[32:35], a[208:211], a[192:195], 0
    v_mfma_f32_16x16x32_bf16 v[32:35], a[212:215], a[196:199], v[32:35]
    v_mfma_f32_16x16x32_bf16 v[32:35], a[216:219], a[200:203], v[32:35]
    v_mfma_f32_16x16x32_bf16 v[32:35], a[220:223], a[204:207], v[32:35]
    v_mfma_f32_16x16x32_bf16 v[40:43], a[0:3], a[192:195], 0
    v_mfma_f32_16x16x32_bf16 v[40:43], a[4:7], a[196:199], v[40:43]
    v_mfma_f32_16x16x32_bf16 v[40:43], a[8:11], a[200:203], v[40:43]
    v_mfma_f32_16x16x32_bf16 v[40:43], a[12:15], a[204:207], v[40:43]
    v_mfma_f32_16x16x32_bf16 v[44:47], a[16:19], a[192:195], 0
    v_mfma_f32_16x16x32_bf16 v[44:47], a[20:23], a[196:199], v[44:47]
    v_mfma_f32_16x16x32_bf16 v[44:47], a[24:27], a[200:203], v[44:47]
    v_mfma_f32_16x16x32_bf16 v[44:47], a[28:31], a[204:207], v[44:47]
    s_waitcnt vmcnt(4)
    buffer_load_dwordx4 v25, s[20:23], s46 offen offset:1024 nt lds
    s_nop 7
    v_max3_f32 v19, v40, v41, v42
    v_max3_f32 v20, v43, v44, v45
    v_max3_f32 v19, v19, v46, v47
    v_max_f32 v19, v19, v20
    v_mov_b32 v20, v19
    s_nop 1
    v_permlane32_swap_b32 v19, v20
    v_max_f32 v19, v19, v20
    v_mov_b32 v20, v19
    s_nop 1
    v_permlane16_swap_b32 v19, v20
    v_max_f32 v19, v19, v20
    v_mul_f32 v19, s50, v19
    v_max_f32 v19, v19, v16
    v_sub_f32 v18, v16, v19
    v_mov_b32 v16, v19
    v_exp_f32 v18, v18
    v_fma_f32 v40, v40, s50, -v19
    v_fma_f32 v41, v41, s50, -v19
    v_fma_f32 v42, v42, s50, -v19
    v_fma_f32 v43, v43, s50, -v19
    v_fma_f32 v44, v44, s50, -v19
    v_fma_f32 v45, v45, s50, -v19
    v_fma_f32 v46, v46, s50, -v19
    v_fma_f32 v47, v47, s50, -v19
    s_waitcnt vmcnt(4)
    buffer_load_dwordx4 v26, s[20:23], s46 offen offset:2048 nt lds
    v_exp_f32 v40, v40
    v_exp_f32 v41, v41
    v_exp_f32 v42, v42
    v_exp_f32 v43, v43
    v_exp_f32 v44, v44
    v_exp_f32 v45, v45
    v_exp_f32 v46, v46
    v_exp_f32 v47, v47
    v_mul_f32 v17, v17, v18
    v_cvt_pk_bf16_f32 v48, v40, v41
    v_cvt_pk_bf16_f32 v49, v42, v43
    v_cvt_pk_bf16_f32 v50, v44, v45
    v_cvt_pk_bf16_f32 v51, v46, v47
    ds_write_b32 v6, v18
    ds_write_b128 v23, v[48:51]
    v_add_f32 v19, v40, v41
    v_add_f32 v20, v42, v43
    v_add_f32 v21, v44, v45
    v_add_f32 v19, v19, v20
    v_add_f32 v20, v46, v47
    v_add_f32 v21, v21, v20
    v_add_f32 v19, v19, v21
    v_add_f32 v17, v17, v19
    v_add_u32 v6, 544, v6
    v_add_u32 v23, 544, v23
    s_waitcnt vmcnt(4)
    buffer_load_dwordx4 v27, s[20:23], s46 offen offset:3072 nt lds
    ds_read_b128 a[208:211], v28 offset:12288
    ds_read_b128 a[212:215], v29 offset:12288
    ds_read_b128 a[216:219], v30 offset:12288
    ds_read_b128 a[220:223], v31 offset:12288
    s_waitcnt vmcnt(4)
    s_add_u32 s46, s47, 196608
    s_add_u32 m0, s63, 8192
    s_nop 0
    buffer_load_dwordx4 v24, s[20:23], s46 offen offset:0 nt lds
    s_waitcnt lgkmcnt(0)
    v_mfma_f32_16x16x32_bf16 v[36:39], a[208:211], a[192:195], 0
    v_mfma_f32_16x16x32_bf16 v[36:39], a[212:215], a[196:199], v[36:39]
    v_mfma_f32_16x16x32_bf16 v[36:39], a[216:219], a[200:203], v[36:39]
    v_mfma_f32_16x16x32_bf16 v[36:39], a[220:223], a[204:207], v[36:39]
    s_waitcnt vmcnt(4)
    buffer_load_dwordx4 v25, s[20:23], s46 offen offset:1024 nt lds
    s_nop 7
    v_max3_f32 v19, v32, v33, v34
    v_max3_f32 v20, v35, v36, v37
    v_max3_f32 v19, v19, v38, v39
    v_max_f32 v19, v19, v20
    v_mov_b32 v20, v19
    s_nop 1
    v_permlane32_swap_b32 v19, v20
    v_max_f32 v19, v19, v20
    v_mov_b32 v20, v19
    s_nop 1
    v_permlane16_swap_b32 v19, v20
    v_max_f32 v19, v19, v20
    v_mul_f32 v19, s50, v19
    v_max_f32 v19, v19, v16
    v_sub_f32 v18, v16, v19
    v_mov_b32 v16, v19
    v_exp_f32 v18, v18
    v_fma_f32 v32, v32, s50, -v19
    v_fma_f32 v33, v33, s50, -v19
    v_fma_f32 v34, v34, s50, -v19
    v_fma_f32 v35, v35, s50, -v19
    v_fma_f32 v36, v36, s50, -v19
    v_fma_f32 v37, v37, s50, -v19
    v_fma_f32 v38, v38, s50, -v19
    v_fma_f32 v39, v39, s50, -v19
    s_waitcnt vmcnt(4)
    buffer_load_dwordx4 v26, s[20:23], s46 offen offset:2048 nt lds
    v_exp_f32 v32, v32
    v_exp_f32 v33, v33
    v_exp_f32 v34, v34
    v_exp_f32 v35, v35
    v_exp_f32 v36, v36
    v_exp_f32 v37, v37
    v_exp_f32 v38, v38
    v_exp_f32 v39, v39
    v_mul_f32 v17, v17, v18
    v_cvt_pk_bf16_f32 v48, v32, v33
    v_cvt_pk_bf16_f32 v49, v34, v35
    v_cvt_pk_bf16_f32 v50, v36, v37
    v_cvt_pk_bf16_f32 v51, v38, v39
    ds_write_b32 v6, v18
    ds_write_b128 v23, v[48:51]
    v_add_f32 v19, v32, v33
    v_add_f32 v20, v34, v35
    v_add_f32 v21, v36, v37
    v_add_f32 v19, v19, v20
    v_add_f32 v20, v38, v39
    v_add_f32 v21, v21, v20
    v_add_f32 v19, v19, v21
    v_add_f32 v17, v17, v19
    v_add_u32 v6, 544, v6
    v_add_u32 v23, 544, v23
    s_waitcnt vmcnt(4)
    buffer_load_dwordx4 v27, s[20:23], s46 offen offset:3072 nt lds
    ds_read_b128 a[208:211], v28 offset:0
    ds_read_b128 a[212:215], v29 offset:0
    ds_read_b128 a[216:219], v30 offset:0
    ds_read_b128 a[220:223], v31 offset:0
    s_waitcnt vmcnt(4)
    s_xor_b32 s46, s46, 4096
    s_add_u32 m0, s63, 12288
    s_nop 0
    buffer_load_dwordx4 v24, s[20:23], s46 offen offset:0 nt lds
    s_waitcnt lgkmcnt(0)
    v_mfma_f32_16x16x32_bf16 v[32:35], a[208:211], a[192:195], 0
    v_mfma_f32_16x16x32_bf16 v[32:35], a[212:215], a[196:199], v[32:35]
    v_mfma_f32_16x16x32_bf16 v[32:35], a[216:219], a[200:203], v[32:35]
    v_mfma_f32_16x16x32_bf16 v[32:35], a[220:223], a[204:207], v[32:35]
    v_mfma_f32_16x16x32_bf16 v[40:43], a[32:35], a[192:195], 0
    v_mfma_f32_16x16x32_bf16 v[40:43], a[36:39], a[196:199], v[40:43]
    v_mfma_f32_16x16x32_bf16 v[40:43], a[40:43], a[200:203], v[40:43]
    v_mfma_f32_16x16x32_bf16 v[40:43], a[44:47], a[204:207], v[40:43]
    v_mfma_f32_16x16x32_bf16 v[44:47], a[48:51], a[192:195], 0
    v_mfma_f32_16x16x32_bf16 v[44:47], a[52:55], a[196:199], v[44:47]
    v_mfma_f32_16x16x32_bf16 v[44:47], a[56:59], a[200:203], v[44:47]
    v_mfma_f32_16x16x32_bf16 v[44:47], a[60:63], a[204:207], v[44:47]
    s_waitcnt vmcnt(4)
    buffer_load_dwordx4 v25, s[20:23], s46 offen offset:1024 nt lds
    s_nop 7
    v_max3_f32 v19, v40, v41, v42
    v_max3_f32 v20, v43, v44, v45
    v_max3_f32 v19, v19, v46, v47
    v_max_f32 v19, v19, v20
    v_mov_b32 v20, v19
    s_nop 1
    v_permlane32_swap_b32 v19, v20
    v_max_f32 v19, v19, v20
    v_mov_b32 v20, v19
    s_nop 1
    v_permlane16_swap_b32 v19, v20
    v_max_f32 v19, v19, v20
    v_mul_f32 v19, s50, v19
    v_max_f32 v19, v19, v16
    v_sub_f32 v18, v16, v19
    v_mov_b32 v16, v19
    v_exp_f32 v18, v18
    v_fma_f32 v40, v40, s50, -v19
    v_fma_f32 v41, v41, s50, -v19
    v_fma_f32 v42, v42, s50, -v19
    v_fma_f32 v43, v43, s50, -v19
    v_fma_f32 v44, v44, s50, -v19
    v_fma_f32 v45, v45, s50, -v19
    v_fma_f32 v46, v46, s50, -v19
    v_fma_f32 v47, v47, s50, -v19
    s_waitcnt vmcnt(4)
    buffer_load_dwordx4 v26, s[20:23], s46 offen offset:2048 nt lds
    v_exp_f32 v40, v40
    v_exp_f32 v41, v41
    v_exp_f32 v42, v42
    v_exp_f32 v43, v43
    v_exp_f32 v44, v44
    v_exp_f32 v45, v45
    v_exp_f32 v46, v46
    v_exp_f32 v47, v47
    v_mul_f32 v17, v17, v18
    v_cvt_pk_bf16_f32 v48, v40, v41
    v_cvt_pk_bf16_f32 v49, v42, v43
    v_cvt_pk_bf16_f32 v50, v44, v45
    v_cvt_pk_bf16_f32 v51, v46, v47
    ds_write_b32 v6, v18
    ds_write_b128 v23, v[48:51]
    v_add_f32 v19, v40, v41
    v_add_f32 v20, v42, v43
    v_add_f32 v21, v44, v45
    v_add_f32 v19, v19, v20
    v_add_f32 v20, v46, v47
    v_add_f32 v21, v21, v20
    v_add_f32 v19, v19, v21
    v_add_f32 v17, v17, v19
    v_add_u32 v6, 544, v6
    v_add_u32 v23, 544, v23
    s_waitcnt vmcnt(4)
    buffer_load_dwordx4 v27, s[20:23], s46 offen offset:3072 nt lds
    ds_read_b128 a[208:211], v28 offset:4096
    ds_read_b128 a[212:215], v29 offset:4096
    ds_read_b128 a[216:219], v30 offset:4096
    ds_read_b128 a[220:223], v31 offset:4096
    s_waitcnt vmcnt(4)
    s_add_u32 s46, s47, 262144
    s_add_u32 m0, s63, 0
    s_nop 0
    buffer_load_dwordx4 v24, s[20:23], s46 offen offset:0 nt lds
    s_waitcnt lgkmcnt(0)
    v_mfma_f32_16x16x32_bf16 v[36:39], a[208:211], a[192:195], 0
    v_mfma_f32_16x16x32_bf16 v[36:39], a[212:215], a[196:199], v[36:39]
    v_mfma_f32_16x16x32_bf16 v[36:39], a[216:219], a[200:203], v[36:39]
    v_mfma_f32_16x16x32_bf16 v[36:39], a[220:223], a[204:207], v[36:39]
    s_waitcnt vmcnt(4)
    buffer_load_dwordx4 v25, s[20:23], s46 offen offset:1024 nt lds
    s_nop 7
    v_max3_f32 v19, v32, v33, v34
    v_max3_f32 v20, v35, v36, v37
    v_max3_f32 v19, v19, v38, v39
    v_max_f32 v19, v19, v20
    v_mov_b32 v20, v19
    s_nop 1
    v_permlane32_swap_b32 v19, v20
    v_max_f32 v19, v19, v20
    v_mov_b32 v20, v19
    s_nop 1
    v_permlane16_swap_b32 v19, v20
    v_max_f32 v19, v19, v20
    v_mul_f32 v19, s50, v19
    v_max_f32 v19, v19, v16
    v_sub_f32 v18, v16, v19
    v_mov_b32 v16, v19
    v_exp_f32 v18, v18
    v_fma_f32 v32, v32, s50, -v19
    v_fma_f32 v33, v33, s50, -v19
    v_fma_f32 v34, v34, s50, -v19
    v_fma_f32 v35, v35, s50, -v19
    v_fma_f32 v36, v36, s50, -v19
    v_fma_f32 v37, v37, s50, -v19
    v_fma_f32 v38, v38, s50, -v19
    v_fma_f32 v39, v39, s50, -v19
    s_waitcnt vmcnt(4)
    buffer_load_dwordx4 v26, s[20:23], s46 offen offset:2048 nt lds
    v_exp_f32 v32, v32
    v_exp_f32 v33, v33
    v_exp_f32 v34, v34
    v_exp_f32 v35, v35
    v_exp_f32 v36, v36
    v_exp_f32 v37, v37
    v_exp_f32 v38, v38
    v_exp_f32 v39, v39
    v_mul_f32 v17, v17, v18
    v_cvt_pk_bf16_f32 v48, v32, v33
    v_cvt_pk_bf16_f32 v49, v34, v35
    v_cvt_pk_bf16_f32 v50, v36, v37
    v_cvt_pk_bf16_f32 v51, v38, v39
    ds_write_b32 v6, v18
    ds_write_b128 v23, v[48:51]
    v_add_f32 v19, v32, v33
    v_add_f32 v20, v34, v35
    v_add_f32 v21, v36, v37
    v_add_f32 v19, v19, v20
    v_add_f32 v20, v38, v39
    v_add_f32 v21, v21, v20
    v_add_f32 v19, v19, v21
    v_add_f32 v17, v17, v19
    v_add_u32 v6, 544, v6
    v_add_u32 v23, 544, v23
    s_waitcnt vmcnt(4)
    buffer_load_dwordx4 v27, s[20:23], s46 offen offset:3072 nt lds
    ds_read_b128 a[208:211], v28 offset:8192
    ds_read_b128 a[212:215], v29 offset:8192
    ds_read_b128 a[216:219], v30 offset:8192
    ds_read_b128 a[220:223], v31 offset:8192
    s_waitcnt vmcnt(4)
    s_xor_b32 s46, s46, 4096
    s_add_u32 m0, s63, 4096
    s_nop 0
    buffer_load_dwordx4 v24, s[20:23], s46 offen offset:0 nt lds
    s_waitcnt lgkmcnt(0)
    v_mfma_f32_16x16x32_bf16 v[32:35], a[208:211], a[192:195], 0
    v_mfma_f32_16x16x32_bf16 v[32:35], a[212:215], a[196:199], v[32:35]
    v_mfma_f32_16x16x32_bf16 v[32:35], a[216:219], a[200:203], v[32:35]
    v_mfma_f32_16x16x32_bf16 v[32:35], a[220:223], a[204:207], v[32:35]
    v_mfma_f32_16x16x32_bf16 v[40:43], a[64:67], a[192:195], 0
    v_mfma_f32_16x16x32_bf16 v[40:43], a[68:71], a[196:199], v[40:43]
    v_mfma_f32_16x16x32_bf16 v[40:43], a[72:75], a[200:203], v[40:43]
    v_mfma_f32_16x16x32_bf16 v[40:43], a[76:79], a[204:207], v[40:43]
    v_mfma_f32_16x16x32_bf16 v[44:47], a[80:83], a[192:195], 0
    v_mfma_f32_16x16x32_bf16 v[44:47], a[84:87], a[196:199], v[44:47]
    v_mfma_f32_16x16x32_bf16 v[44:47], a[88:91], a[200:203], v[44:47]
    v_mfma_f32_16x16x32_bf16 v[44:47], a[92:95], a[204:207], v[44:47]
    s_waitcnt vmcnt(4)
    buffer_load_dwordx4 v25, s[20:23], s46 offen offset:1024 nt lds
    s_nop 7
    v_max3_f32 v19, v40, v41, v42
    v_max3_f32 v20, v43, v44, v45
    v_max3_f32 v19, v19, v46, v47
    v_max_f32 v19, v19, v20
    v_mov_b32 v20, v19
    s_nop 1
    v_permlane32_swap_b32 v19, v20
    v_max_f32 v19, v19, v20
    v_mov_b32 v20, v19
    s_nop 1
    v_permlane16_swap_b32 v19, v20
    v_max_f32 v19, v19, v20
    v_mul_f32 v19, s50, v19
    v_max_f32 v19, v19, v16
    v_sub_f32 v18, v16, v19
    v_mov_b32 v16, v19
    v_exp_f32 v18, v18
    v_fma_f32 v40, v40, s50, -v19
    v_fma_f32 v41, v41, s50, -v19
    v_fma_f32 v42, v42, s50, -v19
    v_fma_f32 v43, v43, s50, -v19
    v_fma_f32 v44, v44, s50, -v19
    v_fma_f32 v45, v45, s50, -v19
    v_fma_f32 v46, v46, s50, -v19
    v_fma_f32 v47, v47, s50, -v19
    s_waitcnt vmcnt(4)
    buffer_load_dwordx4 v26, s[20:23], s46 offen offset:2048 nt lds
    v_exp_f32 v40, v40
    v_exp_f32 v41, v41
    v_exp_f32 v42, v42
    v_exp_f32 v43, v43
    v_exp_f32 v44, v44
    v_exp_f32 v45, v45
    v_exp_f32 v46, v46
    v_exp_f32 v47, v47
    v_mul_f32 v17, v17, v18
    v_cvt_pk_bf16_f32 v48, v40, v41
    v_cvt_pk_bf16_f32 v49, v42, v43
    v_cvt_pk_bf16_f32 v50, v44, v45
    v_cvt_pk_bf16_f32 v51, v46, v47
    ds_write_b32 v6, v18
    ds_write_b128 v23, v[48:51]
    v_add_f32 v19, v40, v41
    v_add_f32 v20, v42, v43
    v_add_f32 v21, v44, v45
    v_add_f32 v19, v19, v20
    v_add_f32 v20, v46, v47
    v_add_f32 v21, v21, v20
    v_add_f32 v19, v19, v21
    v_add_f32 v17, v17, v19
    v_add_u32 v6, 544, v6
    v_add_u32 v23, 544, v23
    s_waitcnt vmcnt(4)
    buffer_load_dwordx4 v27, s[20:23], s46 offen offset:3072 nt lds
    ds_read_b128 a[208:211], v28 offset:12288
    ds_read_b128 a[212:215], v29 offset:12288
    ds_read_b128 a[216:219], v30 offset:12288
    ds_read_b128 a[220:223], v31 offset:12288
    s_waitcnt vmcnt(4)
    s_add_u32 s46, s47, 327680
    s_add_u32 m0, s63, 8192
    s_nop 0
    buffer_load_dwordx4 v24, s[20:23], s46 offen offset:0 nt lds
    s_waitcnt lgkmcnt(0)
    v_mfma_f32_16x16x32_bf16 v[36:39], a[208:211], a[192:195], 0
    v_mfma_f32_16x16x32_bf16 v[36:39], a[212:215], a[196:199], v[36:39]
    v_mfma_f32_16x16x32_bf16 v[36:39], a[216:219], a[200:203], v[36:39]
    v_mfma_f32_16x16x32_bf16 v[36:39], a[220:223], a[204:207], v[36:39]
    s_waitcnt vmcnt(4)
    buffer_load_dwordx4 v25, s[20:23], s46 offen offset:1024 nt lds
    s_nop 7
    v_max3_f32 v19, v32, v33, v34
    v_max3_f32 v20, v35, v36, v37
    v_max3_f32 v19, v19, v38, v39
    v_max_f32 v19, v19, v20
    v_mov_b32 v20, v19
    s_nop 1
    v_permlane32_swap_b32 v19, v20
    v_max_f32 v19, v19, v20
    v_mov_b32 v20, v19
    s_nop 1
    v_permlane16_swap_b32 v19, v20
    v_max_f32 v19, v19, v20
    v_mul_f32 v19, s50, v19
    v_max_f32 v19, v19, v16
    v_sub_f32 v18, v16, v19
    v_mov_b32 v16, v19
    v_exp_f32 v18, v18
    v_fma_f32 v32, v32, s50, -v19
    v_fma_f32 v33, v33, s50, -v19
    v_fma_f32 v34, v34, s50, -v19
    v_fma_f32 v35, v35, s50, -v19
    v_fma_f32 v36, v36, s50, -v19
    v_fma_f32 v37, v37, s50, -v19
    v_fma_f32 v38, v38, s50, -v19
    v_fma_f32 v39, v39, s50, -v19
    s_waitcnt vmcnt(4)
    buffer_load_dwordx4 v26, s[20:23], s46 offen offset:2048 nt lds
    v_exp_f32 v32, v32
    v_exp_f32 v33, v33
    v_exp_f32 v34, v34
    v_exp_f32 v35, v35
    v_exp_f32 v36, v36
    v_exp_f32 v37, v37
    v_exp_f32 v38, v38
    v_exp_f32 v39, v39
    v_mul_f32 v17, v17, v18
    v_cvt_pk_bf16_f32 v48, v32, v33
    v_cvt_pk_bf16_f32 v49, v34, v35
    v_cvt_pk_bf16_f32 v50, v36, v37
    v_cvt_pk_bf16_f32 v51, v38, v39
    ds_write_b32 v6, v18
    ds_write_b128 v23, v[48:51]
    v_add_f32 v19, v32, v33
    v_add_f32 v20, v34, v35
    v_add_f32 v21, v36, v37
    v_add_f32 v19, v19, v20
    v_add_f32 v20, v38, v39
    v_add_f32 v21, v21, v20
    v_add_f32 v19, v19, v21
    v_add_f32 v17, v17, v19
    v_add_u32 v6, 544, v6
    v_add_u32 v23, 544, v23
    s_waitcnt vmcnt(4)
    buffer_load_dwordx4 v27, s[20:23], s46 offen offset:3072 nt lds
    ds_read_b128 a[208:211], v28 offset:0
    ds_read_b128 a[212:215], v29 offset:0
    ds_read_b128 a[216:219], v30 offset:0
    ds_read_b128 a[220:223], v31 offset:0
    s_waitcnt vmcnt(4)
    s_xor_b32 s46, s46, 4096
    s_add_u32 m0, s63, 12288
    s_nop 0
    buffer_load_dwordx4 v24, s[20:23], s46 offen offset:0 nt lds
    s_waitcnt lgkmcnt(0)
    v_mfma_f32_16x16x32_bf16 v[32:35], a[208:211], a[192:195], 0
    v_mfma_f32_16x16x32_bf16 v[32:35], a[212:215], a[196:199], v[32:35]
    v_mfma_f32_16x16x32_bf16 v[32:35], a[216:219], a[200:203], v[32:35]
    v_mfma_f32_16x16x32_bf16 v[32:35], a[220:223], a[204:207], v[32:35]
    v_mfma_f32_16x16x32_bf16 v[40:43], a[96:99], a[192:195], 0
    v_mfma_f32_16x16x32_bf16 v[40:43], a[100:103], a[196:199], v[40:43]
    v_mfma_f32_16x16x32_bf16 v[40:43], a[104:107], a[200:203], v[40:43]
    v_mfma_f32_16x16x32_bf16 v[40:43], a[108:111], a[204:207], v[40:43]
    v_mfma_f32_16x16x32_bf16 v[44:47], a[112:115], a[192:195], 0
    v_mfma_f32_16x16x32_bf16 v[44:47], a[116:119], a[196:199], v[44:47]
    v_mfma_f32_16x16x32_bf16 v[44:47], a[120:123], a[200:203], v[44:47]
    v_mfma_f32_16x16x32_bf16 v[44:47], a[124:127], a[204:207], v[44:47]
    s_waitcnt vmcnt(4)
    buffer_load_dwordx4 v25, s[20:23], s46 offen offset:1024 nt lds
    s_nop 7
    v_max3_f32 v19, v40, v41, v42
    v_max3_f32 v20, v43, v44, v45
    v_max3_f32 v19, v19, v46, v47
    v_max_f32 v19, v19, v20
    v_mov_b32 v20, v19
    s_nop 1
    v_permlane32_swap_b32 v19, v20
    v_max_f32 v19, v19, v20
    v_mov_b32 v20, v19
    s_nop 1
    v_permlane16_swap_b32 v19, v20
    v_max_f32 v19, v19, v20
    v_mul_f32 v19, s50, v19
    v_max_f32 v19, v19, v16
    v_sub_f32 v18, v16, v19
    v_mov_b32 v16, v19
    v_exp_f32 v18, v18
    v_fma_f32 v40, v40, s50, -v19
    v_fma_f32 v41, v41, s50, -v19
    v_fma_f32 v42, v42, s50, -v19
    v_fma_f32 v43, v43, s50, -v19
    v_fma_f32 v44, v44, s50, -v19
    v_fma_f32 v45, v45, s50, -v19
    v_fma_f32 v46, v46, s50, -v19
    v_fma_f32 v47, v47, s50, -v19
    s_waitcnt vmcnt(4)
    buffer_load_dwordx4 v26, s[20:23], s46 offen offset:2048 nt lds
    v_exp_f32 v40, v40
    v_exp_f32 v41, v41
    v_exp_f32 v42, v42
    v_exp_f32 v43, v43
    v_exp_f32 v44, v44
    v_exp_f32 v45, v45
    v_exp_f32 v46, v46
    v_exp_f32 v47, v47
    v_mul_f32 v17, v17, v18
    v_cvt_pk_bf16_f32 v48, v40, v41
    v_cvt_pk_bf16_f32 v49, v42, v43
    v_cvt_pk_bf16_f32 v50, v44, v45
    v_cvt_pk_bf16_f32 v51, v46, v47
    ds_write_b32 v6, v18
    ds_write_b128 v23, v[48:51]
    v_add_f32 v19, v40, v41
    v_add_f32 v20, v42, v43
    v_add_f32 v21, v44, v45
    v_add_f32 v19, v19, v20
    v_add_f32 v20, v46, v47
    v_add_f32 v21, v21, v20
    v_add_f32 v19, v19, v21
    v_add_f32 v17, v17, v19
    v_add_u32 v6, 544, v6
    v_add_u32 v23, 544, v23
    s_waitcnt vmcnt(4)
    buffer_load_dwordx4 v27, s[20:23], s46 offen offset:3072 nt lds
    ds_read_b128 a[208:211], v28 offset:4096
    ds_read_b128 a[212:215], v29 offset:4096
    ds_read_b128 a[216:219], v30 offset:4096
    ds_read_b128 a[220:223], v31 offset:4096
    s_waitcnt vmcnt(4)
    s_mov_b32 s46, s44
    s_add_u32 s44, s46, 0x10000
    s_add_u32 m0, s63, 0
    s_nop 0
    buffer_load_dwordx4 v24, s[20:23], s46 offen offset:0 nt lds
    s_waitcnt lgkmcnt(0)
    v_mfma_f32_16x16x32_bf16 v[36:39], a[208:211], a[192:195], 0
    v_mfma_f32_16x16x32_bf16 v[36:39], a[212:215], a[196:199], v[36:39]
    v_mfma_f32_16x16x32_bf16 v[36:39], a[216:219], a[200:203], v[36:39]
    v_mfma_f32_16x16x32_bf16 v[36:39], a[220:223], a[204:207], v[36:39]
    s_waitcnt vmcnt(4)
    buffer_load_dwordx4 v25, s[20:23], s46 offen offset:1024 nt lds
    s_nop 7
    v_max3_f32 v19, v32, v33, v34
    v_max3_f32 v20, v35, v36, v37
    v_max3_f32 v19, v19, v38, v39
    v_max_f32 v19, v19, v20
    v_mov_b32 v20, v19
    s_nop 1
    v_permlane32_swap_b32 v19, v20
    v_max_f32 v19, v19, v20
    v_mov_b32 v20, v19
    s_nop 1
    v_permlane16_swap_b32 v19, v20
    v_max_f32 v19, v19, v20
    v_mul_f32 v19, s50, v19
    v_max_f32 v19, v19, v16
    v_sub_f32 v18, v16, v19
    v_mov_b32 v16, v19
    v_exp_f32 v18, v18
    v_fma_f32 v32, v32, s50, -v19
    v_fma_f32 v33, v33, s50, -v19
    v_fma_f32 v34, v34, s50, -v19
    v_fma_f32 v35, v35, s50, -v19
    v_fma_f32 v36, v36, s50, -v19
    v_fma_f32 v37, v37, s50, -v19
    v_fma_f32 v38, v38, s50, -v19
    v_fma_f32 v39, v39, s50, -v19
    s_waitcnt vmcnt(4)
    buffer_load_dwordx4 v26, s[20:23], s46 offen offset:2048 nt lds
    v_exp_f32 v32, v32
    v_exp_f32 v33, v33
    v_exp_f32 v34, v34
    v_exp_f32 v35, v35
    v_exp_f32 v36, v36
    v_exp_f32 v37, v37
    v_exp_f32 v38, v38
    v_exp_f32 v39, v39
    v_mul_f32 v17, v17, v18
    v_cvt_pk_bf16_f32 v48, v32, v33
    v_cvt_pk_bf16_f32 v49, v34, v35
    v_cvt_pk_bf16_f32 v50, v36, v37
    v_cvt_pk_bf16_f32 v51, v38, v39
    ds_write_b32 v6, v18
    ds_write_b128 v23, v[48:51]
    v_add_f32 v19, v32, v33
    v_add_f32 v20, v34, v35
    v_add_f32 v21, v36, v37
    v_add_f32 v19, v19, v20
    v_add_f32 v20, v38, v39
    v_add_f32 v21, v21, v20
    v_add_f32 v19, v19, v21
    v_add_f32 v17, v17, v19
    v_add_u32 v6, 544, v6
    v_add_u32 v23, 544, v23
    s_waitcnt vmcnt(4)
    buffer_load_dwordx4 v27, s[20:23], s46 offen offset:3072 nt lds
    ds_read_b128 a[208:211], v28 offset:8192
    ds_read_b128 a[212:215], v29 offset:8192
    ds_read_b128 a[216:219], v30 offset:8192
    ds_read_b128 a[220:223], v31 offset:8192
    s_waitcnt vmcnt(4)
    s_xor_b32 s46, s46, 4096
    s_add_u32 m0, s63, 4096
    s_nop 0
    buffer_load_dwordx4 v24, s[20:23], s46 offen offset:0 nt lds
    s_waitcnt lgkmcnt(0)
    v_mfma_f32_16x16x32_bf16 v[32:35], a[208:211], a[192:195], 0
    v_mfma_f32_16x16x32_bf16 v[32:35], a[212:215], a[196:199], v[32:35]
    v_mfma_f32_16x16x32_bf16 v[32:35], a[216:219], a[200:203], v[32:35]
    v_mfma_f32_16x16x32_bf16 v[32:35], a[220:223], a[204:207], v[32:35]
    v_mfma_f32_16x16x32_bf16 v[40:43], a[128:131], a[192:195], 0
    v_mfma_f32_16x16x32_bf16 v[40:43], a[132:135], a[196:199], v[40:43]
    v_mfma_f32_16x16x32_bf16 v[40:43], a[136:139], a[200:203], v[40:43]
    v_mfma_f32_16x16x32_bf16 v[40:43], a[140:143], a[204:207], v[40:43]
    v_mfma_f32_16x16x32_bf16 v[44:47], a[144:147], a[192:195], 0
    v_mfma_f32_16x16x32_bf16 v[44:47], a[148:151], a[196:199], v[44:47]
    v_mfma_f32_16x16x32_bf16 v[44:47], a[152:155], a[200:203], v[44:47]
    v_mfma_f32_16x16x32_bf16 v[44:47], a[156:159], a[204:207], v[44:47]
    s_waitcnt vmcnt(4)
    buffer_load_dwordx4 v25, s[20:23], s46 offen offset:1024 nt lds
    s_nop 7
    v_max3_f32 v19, v40, v41, v42
    v_max3_f32 v20, v43, v44, v45
    v_max3_f32 v19, v19, v46, v47
    v_max_f32 v19, v19, v20
    v_mov_b32 v20, v19
    s_nop 1
    v_permlane32_swap_b32 v19, v20
    v_max_f32 v19, v19, v20
    v_mov_b32 v20, v19
    s_nop 1
    v_permlane16_swap_b32 v19, v20
    v_max_f32 v19, v19, v20
    v_mul_f32 v19, s50, v19
    v_max_f32 v19, v19, v16
    v_sub_f32 v18, v16, v19
    v_mov_b32 v16, v19
    v_exp_f32 v18, v18
    v_fma_f32 v40, v40, s50, -v19
    v_fma_f32 v41, v41, s50, -v19
    v_fma_f32 v42, v42, s50, -v19
    v_fma_f32 v43, v43, s50, -v19
    v_fma_f32 v44, v44, s50, -v19
    v_fma_f32 v45, v45, s50, -v19
    v_fma_f32 v46, v46, s50, -v19
    v_fma_f32 v47, v47, s50, -v19
    s_waitcnt vmcnt(4)
    buffer_load_dwordx4 v26, s[20:23], s46 offen offset:2048 nt lds
    v_exp_f32 v40, v40
    v_exp_f32 v41, v41
    v_exp_f32 v42, v42
    v_exp_f32 v43, v43
    v_exp_f32 v44, v44
    v_exp_f32 v45, v45
    v_exp_f32 v46, v46
    v_exp_f32 v47, v47
    v_mul_f32 v17, v17, v18
    v_cvt_pk_bf16_f32 v48, v40, v41
    v_cvt_pk_bf16_f32 v49, v42, v43
    v_cvt_pk_bf16_f32 v50, v44, v45
    v_cvt_pk_bf16_f32 v51, v46, v47
    ds_write_b32 v6, v18
    ds_write_b128 v23, v[48:51]
    v_add_f32 v19, v40, v41
    v_add_f32 v20, v42, v43
    v_add_f32 v21, v44, v45
    v_add_f32 v19, v19, v20
    v_add_f32 v20, v46, v47
    v_add_f32 v21, v21, v20
    v_add_f32 v19, v19, v21
    v_add_f32 v17, v17, v19
    v_add_u32 v6, 544, v6
    v_add_u32 v23, 544, v23
    s_waitcnt vmcnt(4)
    buffer_load_dwordx4 v27, s[20:23], s46 offen offset:3072 nt lds
    ds_read_b128 a[208:211], v28 offset:12288
    ds_read_b128 a[212:215], v29 offset:12288
    ds_read_b128 a[216:219], v30 offset:12288
    ds_read_b128 a[220:223], v31 offset:12288
    s_waitcnt vmcnt(4)
    s_mov_b32 s46, s45
    s_add_u32 s45, s46, 0x10000
    s_add_u32 m0, s63, 8192
    s_nop 0
    buffer_load_dwordx4 v24, s[20:23], s46 offen offset:0 nt lds
    s_waitcnt lgkmcnt(0)
    v_mfma_f32_16x16x32_bf16 v[36:39], a[208:211], a[192:195], 0
    v_mfma_f32_16x16x32_bf16 v[36:39], a[212:215], a[196:199], v[36:39]
    v_mfma_f32_16x16x32_bf16 v[36:39], a[216:219], a[200:203], v[36:39]
    v_mfma_f32_16x16x32_bf16 v[36:39], a[220:223], a[204:207], v[36:39]
    s_waitcnt vmcnt(4)
    buffer_load_dwordx4 v25, s[20:23], s46 offen offset:1024 nt lds
    s_nop 7
    v_max3_f32 v19, v32, v33, v34
    v_max3_f32 v20, v35, v36, v37
    v_max3_f32 v19, v19, v38, v39
    v_max_f32 v19, v19, v20
    v_mov_b32 v20, v19
    s_nop 1
    v_permlane32_swap_b32 v19, v20
    v_max_f32 v19, v19, v20
    v_mov_b32 v20, v19
    s_nop 1
    v_permlane16_swap_b32 v19, v20
    v_max_f32 v19, v19, v20
    v_mul_f32 v19, s50, v19
    v_max_f32 v19, v19, v16
    v_sub_f32 v18, v16, v19
    v_mov_b32 v16, v19
    v_exp_f32 v18, v18
    v_fma_f32 v32, v32, s50, -v19
    v_fma_f32 v33, v33, s50, -v19
    v_fma_f32 v34, v34, s50, -v19
    v_fma_f32 v35, v35, s50, -v19
    v_fma_f32 v36, v36, s50, -v19
    v_fma_f32 v37, v37, s50, -v19
    v_fma_f32 v38, v38, s50, -v19
    v_fma_f32 v39, v39, s50, -v19
    s_waitcnt vmcnt(4)
    buffer_load_dwordx4 v26, s[20:23], s46 offen offset:2048 nt lds
    v_exp_f32 v32, v32
    v_exp_f32 v33, v33
    v_exp_f32 v34, v34
    v_exp_f32 v35, v35
    v_exp_f32 v36, v36
    v_exp_f32 v37, v37
    v_exp_f32 v38, v38
    v_exp_f32 v39, v39
    v_mul_f32 v17, v17, v18
    v_cvt_pk_bf16_f32 v48, v32, v33
    v_cvt_pk_bf16_f32 v49, v34, v35
    v_cvt_pk_bf16_f32 v50, v36, v37
    v_cvt_pk_bf16_f32 v51, v38, v39
    ds_write_b32 v6, v18
    ds_write_b128 v23, v[48:51]
    v_add_f32 v19, v32, v33
    v_add_f32 v20, v34, v35
    v_add_f32 v21, v36, v37
    v_add_f32 v19, v19, v20
    v_add_f32 v20, v38, v39
    v_add_f32 v21, v21, v20
    v_add_f32 v19, v19, v21
    v_add_f32 v17, v17, v19
    v_add_u32 v6, 544, v6
    v_add_u32 v23, 544, v23
    s_waitcnt vmcnt(4)
    buffer_load_dwordx4 v27, s[20:23], s46 offen offset:3072 nt lds
    ds_read_b128 a[208:211], v28 offset:0
    ds_read_b128 a[212:215], v29 offset:0
    ds_read_b128 a[216:219], v30 offset:0
    ds_read_b128 a[220:223], v31 offset:0
    s_waitcnt vmcnt(4)
    s_xor_b32 s46, s46, 4096
    s_add_u32 m0, s63, 12288
    s_nop 0
    buffer_load_dwordx4 v24, s[20:23], s46 offen offset:0 nt lds
    s_waitcnt lgkmcnt(0)
    v_mfma_f32_16x16x32_bf16 v[32:35], a[208:211], a[192:195], 0
    v_mfma_f32_16x16x32_bf16 v[32:35], a[212:215], a[196:199], v[32:35]
    v_mfma_f32_16x16x32_bf16 v[32:35], a[216:219], a[200:203], v[32:35]
    v_mfma_f32_16x16x32_bf16 v[32:35], a[220:223], a[204:207], v[32:35]
    v_mfma_f32_16x16x32_bf16 v[40:43], a[160:163], a[192:195], 0
    v_mfma_f32_16x16x32_bf16 v[40:43], a[164:167], a[196:199], v[40:43]
    v_mfma_f32_16x16x32_bf16 v[40:43], a[168:171], a[200:203], v[40:43]
    v_mfma_f32_16x16x32_bf16 v[40:43], a[172:175], a[204:207], v[40:43]
    v_mfma_f32_16x16x32_bf16 v[44:47], a[176:179], a[192:195], 0
    v_mfma_f32_16x16x32_bf16 v[44:47], a[180:183], a[196:199], v[44:47]
    v_mfma_f32_16x16x32_bf16 v[44:47], a[184:187], a[200:203], v[44:47]
    v_mfma_f32_16x16x32_bf16 v[44:47], a[188:191], a[204:207], v[44:47]
    s_waitcnt vmcnt(4)
    buffer_load_dwordx4 v25, s[20:23], s46 offen offset:1024 nt lds
    s_nop 7
    v_max3_f32 v19, v40, v41, v42
    v_max3_f32 v20, v43, v44, v45
    v_max3_f32 v19, v19, v46, v47
    v_max_f32 v19, v19, v20
    v_mov_b32 v20, v19
    s_nop 1
    v_permlane32_swap_b32 v19, v20
    v_max_f32 v19, v19, v20
    v_mov_b32 v20, v19
    s_nop 1
    v_permlane16_swap_b32 v19, v20
    v_max_f32 v19, v19, v20
    v_mul_f32 v19, s50, v19
    v_max_f32 v19, v19, v16
    v_sub_f32 v18, v16, v19
    v_mov_b32 v16, v19
    v_exp_f32 v18, v18
    v_fma_f32 v40, v40, s50, -v19
    v_fma_f32 v41, v41, s50, -v19
    v_fma_f32 v42, v42, s50, -v19
    v_fma_f32 v43, v43, s50, -v19
    v_fma_f32 v44, v44, s50, -v19
    v_fma_f32 v45, v45, s50, -v19
    v_fma_f32 v46, v46, s50, -v19
    v_fma_f32 v47, v47, s50, -v19
    s_waitcnt vmcnt(4)
    buffer_load_dwordx4 v26, s[20:23], s46 offen offset:2048 nt lds
    v_exp_f32 v40, v40
    v_exp_f32 v41, v41
    v_exp_f32 v42, v42
    v_exp_f32 v43, v43
    v_exp_f32 v44, v44
    v_exp_f32 v45, v45
    v_exp_f32 v46, v46
    v_exp_f32 v47, v47
    v_mul_f32 v17, v17, v18
    v_cvt_pk_bf16_f32 v48, v40, v41
    v_cvt_pk_bf16_f32 v49, v42, v43
    v_cvt_pk_bf16_f32 v50, v44, v45
    v_cvt_pk_bf16_f32 v51, v46, v47
    ds_write_b32 v6, v18
    ds_write_b128 v23, v[48:51]
    v_add_f32 v19, v40, v41
    v_add_f32 v20, v42, v43
    v_add_f32 v21, v44, v45
    v_add_f32 v19, v19, v20
    v_add_f32 v20, v46, v47
    v_add_f32 v21, v21, v20
    v_add_f32 v19, v19, v21
    v_add_f32 v17, v17, v19
    v_add_u32 v6, 544, v6
    v_add_u32 v23, 544, v23
    s_waitcnt vmcnt(4)
    buffer_load_dwordx4 v27, s[20:23], s46 offen offset:3072 nt lds
    ds_read_b128 a[208:211], v28 offset:4096
    ds_read_b128 a[212:215], v29 offset:4096
    ds_read_b128 a[216:219], v30 offset:4096
    ds_read_b128 a[220:223], v31 offset:4096
    s_mov_b32 s53, 0
L_loopK:
    s_waitcnt vmcnt(8)
    s_cbranch_vccnz L_dwK0
    s_waitcnt vmcnt(4)
L_dwK0:
    s_barrier
    s_mov_b32 s46, s44
    s_add_u32 s44, s46, 0x10000
    s_add_u32 m0, s63, 0
    s_nop 0
    buffer_load_dwordx4 v24, s[20:23], s46 offen offset:0 nt lds
    s_waitcnt lgkmcnt(0)
    v_mfma_f32_16x16x32_bf16 v[36:39], a[208:211], a[192:195], 0
    v_mfma_f32_16x16x32_bf16 v[36:39], a[212:215], a[196:199], v[36:39]
    v_mfma_f32_16x16x32_bf16 v[36:39], a[216:219], a[200:203], v[36:39]
    v_mfma_f32_16x16x32_bf16 v[36:39], a[220:223], a[204:207], v[36:39]
    s_waitcnt vmcnt(8)
    s_cbranch_vccnz L_dwK1
    s_waitcnt vmcnt(4)
L_dwK1:
    buffer_load_dwordx4 v25, s[20:23], s46 offen offset:1024 nt lds
    s_nop 7
    v_max3_f32 v19, v32, v33, v34
    v_max3_f32 v20, v35, v36, v37
    v_max3_f32 v19, v19, v38, v39
    v_max_f32 v19, v19, v20
    v_mov_b32 v20, v19
    s_nop 1
    v_permlane32_swap_b32 v19, v20
    v_max_f32 v19, v19, v20
    v_mov_b32 v20, v19
    s_nop 1
    v_permlane16_swap_b32 v19, v20
    v_max_f32 v19, v19, v20
    v_mul_f32 v19, s50, v19
    v_max_f32 v19, v19, v16
    v_sub_f32 v18, v16, v19
    v_mov_b32 v16, v19
    v_exp_f32 v18, v18
    v_fma_f32 v32, v32, s50, -v19
    v_fma_f32 v33, v33, s50, -v19
    v_fma_f32 v34, v34, s50, -v19
    v_fma_f32 v35, v35, s50, -v19
    v_fma_f32 v36, v36, s50, -v19
    v_fma_f32 v37, v37, s50, -v19
    v_fma_f32 v38, v38, s50, -v19
    v_fma_f32 v39, v39, s50, -v19
    s_waitcnt vmcnt(8)
    s_cbranch_vccnz L_dwK2
    s_waitcnt vmcnt(4)
L_dwK2:
    buffer_load_dwordx4 v26, s[20:23], s46 offen offset:2048 nt lds
    v_exp_f32 v32, v32
    v_exp_f32 v33, v33
    v_exp_f32 v34, v34
    v_exp_f32 v35, v35
    v_exp_f32 v36, v36
    v_exp_f32 v37, v37
    v_exp_f32 v38, v38
    v_exp_f32 v39, v39
    v_mul_f32 v17, v17, v18
    v_cvt_pk_bf16_f32 v48, v32, v33
    v_cvt_pk_bf16_f32 v49, v34, v35
    v_cvt_pk_bf16_f32 v50, v36, v37
    v_cvt_pk_bf16_f32 v51, v38, v39
    ds_write_b32 v6, v18
    ds_write_b128 v23, v[48:51]
    v_add_f32 v19, v32, v33
    v_add_f32 v20, v34, v35
    v_add_f32 v21, v36, v37
    v_add_f32 v19, v19, v20
    v_add_f32 v20, v38, v39
    v_add_f32 v21, v21, v20
    v_add_f32 v19, v19, v21
    v_add_f32 v17, v17, v19
    v_add_u32 v6, 544, v6
    v_add_u32 v23, 544, v23
    s_waitcnt vmcnt(7)
    s_cbranch_vccnz L_dwK3
    s_waitcnt vmcnt(4)
L_dwK3:
    buffer_load_dwordx4 v27, s[20:23], s46 offen offset:3072 nt lds
    v_cmp_ge_u32 s[90:91], v205, v209
    v_cmp_gt_u32 s[92:93], v205, v209
    s_bcnt1_i32_b32 s51, s90
    s_bcnt1_i32_b32 s94, s92
    s_add_u32 s51, s51, s94
    s_mov_b32 s94, 1
    s_cmp_ge_u32 s51, 31
    s_cselect_b32 s51, 3, s94
    v_mov_b32 v205, s51
    ds_write_b32 v206, v205 offset:19328
    ds_read_b128 a[208:211], v28 offset:8192
    ds_read_b128 a[212:215], v29 offset:8192
    ds_read_b128 a[216:219], v30 offset:8192
    ds_read_b128 a[220:223], v31 offset:8192
    s_waitcnt vmcnt(7)
    s_cbranch_vccnz L_dwK4
    s_waitcnt vmcnt(4)
L_dwK4:
    s_xor_b32 s46, s46, 4096
    s_add_u32 m0, s63, 4096
    s_nop 0
    buffer_load_dwordx4 v24, s[20:23], s46 offen offset:0 nt lds
    s_waitcnt lgkmcnt(0)
    v_mfma_f32_16x16x32_bf16 v[32:35], a[208:211], a[192:195], 0
    v_mfma_f32_16x16x32_bf16 v[32:35], a[212:215], a[196:199], v[32:35]
    v_mfma_f32_16x16x32_bf16 v[32:35], a[216:219], a[200:203], v[32:35]
    v_mfma_f32_16x16x32_bf16 v[32:35], a[220:223], a[204:207], v[32:35]
    s_waitcnt vmcnt(7)
    s_cbranch_vccnz L_dwK5
    s_waitcnt vmcnt(4)
L_dwK5:
    buffer_load_dwordx4 v25, s[20:23], s46 offen offset:1024 nt lds
    s_waitcnt vmcnt(7)
    s_cbranch_vccnz L_dwK6
    s_waitcnt vmcnt(4)
L_dwK6:
    buffer_load_dwordx4 v26, s[20:23], s46 offen offset:2048 nt lds
    s_waitcnt vmcnt(7)
    s_cbranch_vccnz L_dwK7
    s_waitcnt vmcnt(4)
L_dwK7:
    buffer_load_dwordx4 v27, s[20:23], s46 offen offset:3072 nt lds
    ds_read_b128 a[208:211], v28 offset:12288
    ds_read_b128 a[212:215], v29 offset:12288
    ds_read_b128 a[216:219], v30 offset:12288
    ds_read_b128 a[220:223], v31 offset:12288
    s_waitcnt vmcnt(7)
    s_cbranch_vccnz L_dwK8
    s_waitcnt vmcnt(4)
L_dwK8:
    s_barrier
    s_mov_b32 s46, s45
    s_add_u32 s45, s46, 0x10000
    s_add_u32 m0, s63, 8192
    s_nop 0
    buffer_load_dwordx4 v24, s[20:23], s46 offen offset:0 nt lds
    s_waitcnt lgkmcnt(0)
    v_mfma_f32_16x16x32_bf16 v[36:39], a[208:211], a[192:195], 0
    v_mfma_f32_16x16x32_bf16 v[36:39], a[212:215], a[196:199], v[36:39]
    v_mfma_f32_16x16x32_bf16 v[36:39], a[216:219], a[200:203], v[36:39]
    v_mfma_f32_16x16x32_bf16 v[36:39], a[220:223], a[204:207], v[36:39]
    s_waitcnt vmcnt(7)
    s_cbranch_vccnz L_dwK9
    s_waitcnt vmcnt(4)
L_dwK9:
    buffer_load_dwordx4 v25, s[20:23], s46 offen offset:1024 nt lds
    s_nop 7
    v_max3_f32 v19, v32, v33, v34
    v_max3_f32 v20, v35, v36, v37
    v_max3_f32 v19, v19, v38, v39
    v_max_f32 v19, v19, v20
    v_mov_b32 v20, v19
    s_nop 1
    v_permlane32_swap_b32 v19, v20
    v_max_f32 v19, v19, v20
    v_mov_b32 v20, v19
    s_nop 1
    v_permlane16_swap_b32 v19, v20
    v_max_f32 v19, v19, v20
    v_mul_f32 v19, s50, v19
    v_max_f32 v19, v19, v16
    v_sub_f32 v18, v16, v19
    v_mov_b32 v16, v19
    v_exp_f32 v18, v18
    v_fma_f32 v32, v32, s50, -v19
    v_fma_f32 v33, v33, s50, -v19
    v_fma_f32 v34, v34, s50, -v19
    v_fma_f32 v35, v35, s50, -v19
    v_fma_f32 v36, v36, s50, -v19
    v_fma_f32 v37, v37, s50, -v19
    v_fma_f32 v38, v38, s50, -v19
    v_fma_f32 v39, v39, s50, -v19
    s_waitcnt vmcnt(7)
    s_cbranch_vccnz L_dwK10
    s_waitcnt vmcnt(4)
L_dwK10:
    buffer_load_dwordx4 v26, s[20:23], s46 offen offset:2048 nt lds
    v_add_u32 v209, 1, v209
    buffer_load_ubyte v205, v208, s[84:87], 0 offen sc0
    s_mov_b64 exec, 1
    buffer_store_byte v209, v204, s[84:87], 0 offen
    s_mov_b64 exec, -1
    v_exp_f32 v32, v32
    v_exp_f32 v33, v33
    v_exp_f32 v34, v34
    v_exp_f32 v35, v35
    v_exp_f32 v36, v36
    v_exp_f32 v37, v37
    v_exp_f32 v38, v38
    v_exp_f32 v39, v39
    v_mul_f32 v17, v17, v18
    v_cvt_pk_bf16_f32 v48, v32, v33
    v_cvt_pk_bf16_f32 v49, v34, v35
    v_cvt_pk_bf16_f32 v50, v36, v37
    v_cvt_pk_bf16_f32 v51, v38, v39
    ds_write_b32 v6, v18
    ds_write_b128 v23, v[48:51]
    v_add_f32 v19, v32, v33
    v_add_f32 v20, v34, v35
    v_add_f32 v21, v36, v37
    v_add_f32 v19, v19, v20
    v_add_f32 v20, v38, v39
    v_add_f32 v21, v21, v20
    v_add_f32 v19, v19, v21
    v_add_f32 v17, v17, v19
    v_add_u32 v6, 544, v6
    v_add_u32 v23, 544, v23
    s_waitcnt vmcnt(8)
    s_cbranch_vccnz L_dwK11
    s_waitcnt vmcnt(6)
L_dwK11:
    buffer_load_dwordx4 v27, s[20:23], s46 offen offset:3072 nt lds
    v_mov_b32 v207, 0
    ds_read_b32 v207, v207 offset:19328
    ds_read_b128 a[208:211], v28 offset:0
    ds_read_b128 a[212:215], v29 offset:0
    ds_read_b128 a[216:219], v30 offset:0
    ds_read_b128 a[220:223], v31 offset:0
    s_waitcnt vmcnt(8)
    s_cbranch_vccnz L_dwK12
    s_waitcnt vmcnt(6)
L_dwK12:
    s_xor_b32 s46, s46, 4096
    s_add_u32 m0, s63, 12288
    s_nop 0
    buffer_load_dwordx4 v24, s[20:23], s46 offen offset:0 nt lds
    s_waitcnt lgkmcnt(0)
    v_mfma_f32_16x16x32_bf16 v[32:35], a[208:211], a[192:195], 0
    v_mfma_f32_16x16x32_bf16 v[32:35], a[212:215], a[196:199], v[32:35]
    v_mfma_f32_16x16x32_bf16 v[32:35], a[216:219], a[200:203], v[32:35]
    v_mfma_f32_16x16x32_bf16 v[32:35], a[220:223], a[204:207], v[32:35]
    s_waitcnt vmcnt(8)
    s_cbranch_vccnz L_dwK13
    s_waitcnt vmcnt(6)
L_dwK13:
    buffer_load_dwordx4 v25, s[20:23], s46 offen offset:1024 nt lds
    s_waitcnt vmcnt(8)
    s_cbranch_vccnz L_dwK14
    s_waitcnt vmcnt(6)
L_dwK14:
    buffer_load_dwordx4 v26, s[20:23], s46 offen offset:2048 nt lds
    v_readfirstlane_b32 s51, v207
    s_mov_b32 s58, s51
    s_cmp_ge_u32 s51, 3
    s_cselect_b64 vcc, -1, 0
    s_waitcnt vmcnt(8)
    s_cbranch_vccnz L_dwK15
    s_waitcnt vmcnt(6)
L_dwK15:
    buffer_load_dwordx4 v27, s[20:23], s46 offen offset:3072 nt lds
    ds_read_b128 a[208:211], v28 offset:4096
    ds_read_b128 a[212:215], v29 offset:4096
    ds_read_b128 a[216:219], v30 offset:4096
    ds_read_b128 a[220:223], v31 offset:4096
    s_add_u32 s53, s53, 1
    s_cmp_lt_u32 s53, 9
    s_cbranch_scc1 L_loopK
    s_mov_b32 s44, s47
    s_mov_b32 s45, s56
    s_waitcnt vmcnt(8)
    s_cbranch_vccnz L_dwtrans0
    s_waitcnt vmcnt(4)
L_dwtrans0:
    s_barrier
    s_mov_b32 s46, s44
    s_add_u32 s44, s46, 0x10000
    buffer_load_dwordx4 v[108:111], v4, s[24:27], s46 offen offset:0 nt
    s_waitcnt lgkmcnt(0)
    v_mfma_f32_16x16x32_bf16 v[36:39], a[208:211], a[192:195], 0
    v_mfma_f32_16x16x32_bf16 v[36:39], a[212:215], a[196:199], v[36:39]
    v_mfma_f32_16x16x32_bf16 v[36:39], a[216:219], a[200:203], v[36:39]
    v_mfma_f32_16x16x32_bf16 v[36:39], a[220:223], a[204:207], v[36:39]
    s_waitcnt vmcnt(8)
    s_cbranch_vccnz L_dwtrans1
    s_waitcnt vmcnt(4)
L_dwtrans1:
    buffer_load_dwordx4 v[112:115], v4, s[24:27], s46 offen offset:1024 nt
    s_nop 7
    v_max3_f32 v19, v32, v33, v34
    v_max3_f32 v20, v35, v36, v37
    v_max3_f32 v19, v19, v38, v39
    v_max_f32 v19, v19, v20
    v_mov_b32 v20, v19
    s_nop 1
    v_permlane32_swap_b32 v19, v20
    v_max_f32 v19, v19, v20
    v_mov_b32 v20, v19
    s_nop 1
    v_permlane16_swap_b32 v19, v20
    v_max_f32 v19, v19, v20
    v_mul_f32 v19, s50, v19
    v_max_f32 v19, v19, v16
    v_sub_f32 v18, v16, v19
    v_mov_b32 v16, v19
    v_exp_f32 v18, v18
    v_fma_f32 v32, v32, s50, -v19
    v_fma_f32 v33, v33, s50, -v19
    v_fma_f32 v34, v34, s50, -v19
    v_fma_f32 v35, v35, s50, -v19
    v_fma_f32 v36, v36, s50, -v19
    v_fma_f32 v37, v37, s50, -v19
    v_fma_f32 v38, v38, s50, -v19
    v_fma_f32 v39, v39, s50, -v19
    s_waitcnt vmcnt(8)
    s_cbranch_vccnz L_dwtrans2
    s_waitcnt vmcnt(4)
L_dwtrans2:
    buffer_load_dwordx4 v[116:119], v4, s[24:27], s46 offen offset:2048 nt
    v_exp_f32 v32, v32
    v_exp_f32 v33, v33
    v_exp_f32 v34, v34
    v_exp_f32 v35, v35
    v_exp_f32 v36, v36
    v_exp_f32 v37, v37
    v_exp_f32 v38, v38
    v_exp_f32 v39, v39
    v_mul_f32 v17, v17, v18
    v_cvt_pk_bf16_f32 v48, v32, v33
    v_cvt_pk_bf16_f32 v49, v34, v35
    v_cvt_pk_bf16_f32 v50, v36, v37
    v_cvt_pk_bf16_f32 v51, v38, v39
    ds_write_b32 v6, v18
    ds_write_b128 v23, v[48:51]
    v_add_f32 v19, v32, v33
    v_add_f32 v20, v34, v35
    v_add_f32 v21, v36, v37
    v_add_f32 v19, v19, v20
    v_add_f32 v20, v38, v39
    v_add_f32 v21, v21, v20
    v_add_f32 v19, v19, v21
    v_add_f32 v17, v17, v19
    v_add_u32 v6, 544, v6
    v_add_u32 v23, 544, v23
    s_waitcnt vmcnt(7)
    s_cbranch_vccnz L_dwtrans3
    s_waitcnt vmcnt(4)
L_dwtrans3:
    buffer_load_dwordx4 v[120:123], v4, s[24:27], s46 offen offset:3072 nt
    v_cmp_ge_u32 s[90:91], v205, v209
    v_cmp_gt_u32 s[92:93], v205, v209
    s_bcnt1_i32_b32 s51, s90
    s_bcnt1_i32_b32 s94, s92
    s_add_u32 s51, s51, s94
    s_mov_b32 s94, 1
    s_cmp_ge_u32 s51, 31
    s_cselect_b32 s51, 3, s94
    v_mov_b32 v205, s51
    ds_write_b32 v206, v205 offset:19328
    ds_read_b128 a[208:211], v28 offset:8192
    ds_read_b128 a[212:215], v29 offset:8192
    ds_read_b128 a[216:219], v30 offset:8192
    ds_read_b128 a[220:223], v31 offset:8192
    s_waitcnt vmcnt(7)
    s_cbranch_vccnz L_dwtrans4
    s_waitcnt vmcnt(4)
L_dwtrans4:
    s_xor_b32 s46, s46, 4096
    buffer_load_dwordx4 v[124:127], v4, s[24:27], s46 offen offset:0 nt
    s_waitcnt lgkmcnt(0)
    v_mfma_f32_16x16x32_bf16 v[32:35], a[208:211], a[192:195], 0
    v_mfma_f32_16x16x32_bf16 v[32:35], a[212:215], a[196:199], v[32:35]
    v_mfma_f32_16x16x32_bf16 v[32:35], a[216:219], a[200:203], v[32:35]
    v_mfma_f32_16x16x32_bf16 v[32:35], a[220:223], a[204:207], v[32:35]
    s_waitcnt vmcnt(7)
    s_cbranch_vccnz L_dwtrans5
    s_waitcnt vmcnt(4)
L_dwtrans5:
    buffer_load_dwordx4 v[128:131], v4, s[24:27], s46 offen offset:1024 nt
    s_waitcnt vmcnt(7)
    s_cbranch_vccnz L_dwtrans6
    s_waitcnt vmcnt(4)
L_dwtrans6:
    buffer_load_dwordx4 v[132:135], v4, s[24:27], s46 offen offset:2048 nt
    s_waitcnt vmcnt(7)
    s_cbranch_vccnz L_dwtrans7
    s_waitcnt vmcnt(4)
L_dwtrans7:
    buffer_load_dwordx4 v[136:139], v4, s[24:27], s46 offen offset:3072 nt
    ds_read_b128 a[208:211], v28 offset:12288
    ds_read_b128 a[212:215], v29 offset:12288
    ds_read_b128 a[216:219], v30 offset:12288
    ds_read_b128 a[220:223], v31 offset:12288
    s_waitcnt vmcnt(7)
    s_cbranch_vccnz L_dwtrans8
    s_waitcnt vmcnt(4)
L_dwtrans8:
    s_barrier
    s_mov_b32 s46, s45
    s_add_u32 s45, s46, 0x10000
    buffer_load_dwordx4 v[140:143], v4, s[24:27], s46 offen offset:0 nt
    s_waitcnt lgkmcnt(0)
    v_mfma_f32_16x16x32_bf16 v[36:39], a[208:211], a[192:195], 0
    v_mfma_f32_16x16x32_bf16 v[36:39], a[212:215], a[196:199], v[36:39]
    v_mfma_f32_16x16x32_bf16 v[36:39], a[216:219], a[200:203], v[36:39]
    v_mfma_f32_16x16x32_bf16 v[36:39], a[220:223], a[204:207], v[36:39]
    s_waitcnt vmcnt(7)
    s_cbranch_vccnz L_dwtrans9
    s_waitcnt vmcnt(4)
L_dwtrans9:
    buffer_load_dwordx4 v[144:147], v4, s[24:27], s46 offen offset:1024 nt
    s_nop 7
    v_max3_f32 v19, v32, v33, v34
    v_max3_f32 v20, v35, v36, v37
    v_max3_f32 v19, v19, v38, v39
    v_max_f32 v19, v19, v20
    v_mov_b32 v20, v19
    s_nop 1
    v_permlane32_swap_b32 v19, v20
    v_max_f32 v19, v19, v20
    v_mov_b32 v20, v19
    s_nop 1
    v_permlane16_swap_b32 v19, v20
    v_max_f32 v19, v19, v20
    v_mul_f32 v19, s50, v19
    v_max_f32 v19, v19, v16
    v_sub_f32 v18, v16, v19
    v_mov_b32 v16, v19
    v_exp_f32 v18, v18
    v_fma_f32 v32, v32, s50, -v19
    v_fma_f32 v33, v33, s50, -v19
    v_fma_f32 v34, v34, s50, -v19
    v_fma_f32 v35, v35, s50, -v19
    v_fma_f32 v36, v36, s50, -v19
    v_fma_f32 v37, v37, s50, -v19
    v_fma_f32 v38, v38, s50, -v19
    v_fma_f32 v39, v39, s50, -v19
    s_waitcnt vmcnt(7)
    s_cbranch_vccnz L_dwtrans10
    s_waitcnt vmcnt(4)
L_dwtrans10:
    buffer_load_dwordx4 v[148:151], v4, s[24:27], s46 offen offset:2048 nt
    v_add_u32 v209, 1, v209
    buffer_load_ubyte v205, v208, s[84:87], 0 offen sc0
    s_mov_b64 exec, 1
    buffer_store_byte v209, v204, s[84:87], 0 offen
    s_mov_b64 exec, -1
    v_exp_f32 v32, v32
    v_exp_f32 v33, v33
    v_exp_f32 v34, v34
    v_exp_f32 v35, v35
    v_exp_f32 v36, v36
    v_exp_f32 v37, v37
    v_exp_f32 v38, v38
    v_exp_f32 v39, v39
    v_mul_f32 v17, v17, v18
    v_cvt_pk_bf16_f32 v48, v32, v33
    v_cvt_pk_bf16_f32 v49, v34, v35
    v_cvt_pk_bf16_f32 v50, v36, v37
    v_cvt_pk_bf16_f32 v51, v38, v39
    ds_write_b32 v6, v18
    ds_write_b128 v23, v[48:51]
    v_add_f32 v19, v32, v33
    v_add_f32 v20, v34, v35
    v_add_f32 v21, v36, v37
    v_add_f32 v19, v19, v20
    v_add_f32 v20, v38, v39
    v_add_f32 v21, v21, v20
    v_add_f32 v19, v19, v21
    v_add_f32 v17, v17, v19
    v_add_u32 v6, 544, v6
    v_add_u32 v23, 544, v23
    s_waitcnt vmcnt(8)
    s_cbranch_vccnz L_dwtrans11
    s_waitcnt vmcnt(6)
L_dwtrans11:
    buffer_load_dwordx4 v[152:155], v4, s[24:27], s46 offen offset:3072 nt
    v_mov_b32 v207, 0
    ds_read_b32 v207, v207 offset:19328
    v_mov_b32 v19, v17
    s_nop 1
    v_permlane32_swap_b32 v17, v19
    v_add_f32 v17, v17, v19
    v_mov_b32 v19, v17
    s_nop 1
    v_permlane16_swap_b32 v17, v19
    v_add_f32 v17, v17, v19
    v_and_b32 v8, 7, v2
    v_lshlrev_b32 v8, 5, v8
    s_lshl_b32 s51, s3, 3
    v_add_u32 v9, s51, v8
    ds_write_b64 v9, v[16:17] offset:19072
    v_subrev_u32 v6, 17408, v6
    v_subrev_u32 v23, 17408, v23
    s_waitcnt vmcnt(8)
    s_cbranch_vccnz L_dwtrans12
    s_waitcnt vmcnt(6)
L_dwtrans12:
    s_xor_b32 s46, s46, 4096
    buffer_load_dwordx4 v[156:159], v4, s[24:27], s46 offen offset:0 nt
    ds_read_b32 v18, v6
    ds_read_b128 v[48:51], v23
    v_add_u32 v6, 544, v6
    v_add_u32 v23, 544, v23
    s_waitcnt vmcnt(8)
    s_cbranch_vccnz L_dwtrans13
    s_waitcnt vmcnt(6)
L_dwtrans13:
    buffer_load_dwordx4 v[160:163], v4, s[24:27], s46 offen offset:1024 nt
    s_waitcnt lgkmcnt(0)
    v_mul_f32 v60, v60, v18
    v_mul_f32 v61, v61, v18
    v_mul_f32 v62, v62, v18
    v_mul_f32 v63, v63, v18
    v_mul_f32 v64, v64, v18
    v_mul_f32 v65, v65, v18
    v_mul_f32 v66, v66, v18
    v_mul_f32 v67, v67, v18
    v_mul_f32 v68, v68, v18
    v_mul_f32 v69, v69, v18
    v_mul_f32 v70, v70, v18
    v_mul_f32 v71, v71, v18
    v_mul_f32 v72, v72, v18
    v_mul_f32 v73, v73, v18
    v_mul_f32 v74, v74, v18
    v_mul_f32 v75, v75, v18
    v_mul_f32 v76, v76, v18
    v_mul_f32 v77, v77, v18
    v_mul_f32 v78, v78, v18
    v_mul_f32 v79, v79, v18
    v_mul_f32 v80, v80, v18
    v_mul_f32 v81, v81, v18
    v_mul_f32 v82, v82, v18
    v_mul_f32 v83, v83, v18
    v_mul_f32 v84, v84, v18
    v_mul_f32 v85, v85, v18
    v_mul_f32 v86, v86, v18
    v_mul_f32 v87, v87, v18
    v_mul_f32 v88, v88, v18
    v_mul_f32 v89, v89, v18
    v_mul_f32 v90, v90, v18
    v_mul_f32 v91, v91, v18
    s_waitcnt vmcnt(8)
    s_cbranch_vccnz L_dwtrans14
    s_waitcnt vmcnt(6)
L_dwtrans14:
    buffer_load_dwordx4 v[164:167], v4, s[24:27], s46 offen offset:2048 nt
    v_readfirstlane_b32 s51, v207
    s_mov_b32 s58, s51
    s_cmp_ge_u32 s51, 3
    s_cselect_b64 vcc, -1, 0
    s_waitcnt vmcnt(8)
    s_cbranch_vccnz L_dwtrans15
    s_waitcnt vmcnt(6)
L_dwtrans15:
    buffer_load_dwordx4 v[168:171], v4, s[24:27], s46 offen offset:3072 nt
    v_perm_b32 v52, v112, v108, s48
    v_perm_b32 v53, v120, v116, s48
    v_perm_b32 v54, v128, v124, s48
    v_perm_b32 v55, v136, v132, s48
    v_perm_b32 v56, v112, v108, s49
    v_perm_b32 v57, v120, v116, s49
    v_perm_b32 v58, v128, v124, s49
    v_perm_b32 v59, v136, v132, s49
    v_mfma_f32_16x16x32_bf16 v[60:63], v[52:55], v[48:51], v[60:63]
    v_perm_b32 v52, v113, v109, s48
    v_perm_b32 v53, v121, v117, s48
    v_perm_b32 v54, v129, v125, s48
    v_perm_b32 v55, v137, v133, s48
    v_mfma_f32_16x16x32_bf16 v[64:67], v[56:59], v[48:51], v[64:67]
    v_perm_b32 v56, v113, v109, s49
    v_perm_b32 v57, v121, v117, s49
    v_perm_b32 v58, v129, v125, s49
    v_perm_b32 v59, v137, v133, s49
    v_mfma_f32_16x16x32_bf16 v[68:71], v[52:55], v[48:51], v[68:71]
    v_perm_b32 v52, v114, v110, s48
    v_perm_b32 v53, v122, v118, s48
    v_perm_b32 v54, v130, v126, s48
    v_perm_b32 v55, v138, v134, s48
    v_mfma_f32_16x16x32_bf16 v[72:75], v[56:59], v[48:51], v[72:75]
    v_perm_b32 v56, v114, v110, s49
    v_perm_b32 v57, v122, v118, s49
    v_perm_b32 v58, v130, v126, s49
    v_perm_b32 v59, v138, v134, s49
    v_mfma_f32_16x16x32_bf16 v[76:79], v[52:55], v[48:51], v[76:79]
    v_perm_b32 v52, v115, v111, s48
    v_perm_b32 v53, v123, v119, s48
    v_perm_b32 v54, v131, v127, s48
    v_perm_b32 v55, v139, v135, s48
    v_mfma_f32_16x16x32_bf16 v[80:83], v[56:59], v[48:51], v[80:83]
    v_perm_b32 v56, v115, v111, s49
    v_perm_b32 v57, v123, v119, s49
    v_perm_b32 v58, v131, v127, s49
    v_perm_b32 v59, v139, v135, s49
    v_mfma_f32_16x16x32_bf16 v[84:87], v[52:55], v[48:51], v[84:87]
    s_nop 1
    v_mfma_f32_16x16x32_bf16 v[88:91], v[56:59], v[48:51], v[88:91]
    s_barrier
    v_lshrrev_b32 v8, 5, v0
    v_lshlrev_b32 v12, 5, v8
    ds_read_b128 v[52:55], v12 offset:19072
    ds_read_b128 v[56:59], v12 offset:19088
    v_and_b32 v9, 31, v0
    v_mul_u32_u24 v10, 528, v8
    v_lshl_add_u32 v28, v9, 4, v10
    v_mul_u32_u24 v11, 272, v8
    v_lshl_add_u32 v29, v9, 3, v11
    v_lshlrev_b32 v8, 4, v2
    v_lshl_add_u32 v8, v3, 10, v8
    v_cmp_gt_u32 s[88:89], 8, v2
    v_mov_b32 v9, 0x100000
    s_lshl_b32 s62, s3, 12
    v_cndmask_b32 v30, v9, v8, s[88:89]
    s_waitcnt lgkmcnt(0)
    v_max3_f32 v19, v52, v54, v56
    v_max_f32 v19, v19, v58
    v_sub_f32 v52, v52, v19
    v_sub_f32 v54, v54, v19
    v_sub_f32 v56, v56, v19
    v_sub_f32 v58, v58, v19
    v_exp_f32 v52, v52
    v_exp_f32 v54, v54
    v_exp_f32 v56, v56
    v_exp_f32 v58, v58
    s_nop 0
    v_mul_f32 v20, v52, v53
    v_fmac_f32 v20, v54, v55
    v_fmac_f32 v20, v56, v57
    v_fmac_f32 v20, v58, v59
    v_rcp_f32 v20, v20
    s_nop 0
    v_mul_f32 v24, v52, v20
    v_mul_f32 v25, v54, v20
    v_mul_f32 v26, v56, v20
    v_mul_f32 v27, v58, v20
    s_mov_b32 s53, 0
L_loopV:
    s_waitcnt vmcnt(10)
    s_cbranch_vccnz L_dwV10
    s_waitcnt vmcnt(4)
L_dwV10:
    s_barrier
    s_mov_b32 s46, s44
    s_add_u32 s44, s46, 0x10000
    buffer_load_dwordx4 v[108:111], v4, s[24:27], s46 offen offset:0 nt
    s_waitcnt vmcnt(10)
    s_cbranch_vccnz L_dwV11
    s_waitcnt vmcnt(4)
L_dwV11:
    buffer_load_dwordx4 v[112:115], v4, s[24:27], s46 offen offset:1024 nt
    s_lshr_b32 s51, s55, 2
    s_and_b32 s51, s51, 0x3800
    s_add_u32 s51, s51, s63
    s_cmp_lt_u32 s55, 0x20000
    s_cselect_b32 m0, s51, 19456
    s_nop 0
    buffer_load_dwordx4 v7, s[36:39], s55 offen offset:0 nt lds
    buffer_load_dwordx4 v7, s[36:39], s55 offen offset:1024 nt lds
    s_add_u32 s55, s55, 8192
    s_waitcnt vmcnt(10)
    s_cbranch_vccnz L_dwV12
    s_waitcnt vmcnt(6)
L_dwV12:
    buffer_load_dwordx4 v[116:119], v4, s[24:27], s46 offen offset:2048 nt
    s_waitcnt vmcnt(9)
    s_cbranch_vccnz L_dwV13
    s_waitcnt vmcnt(6)
L_dwV13:
    buffer_load_dwordx4 v[120:123], v4, s[24:27], s46 offen offset:3072 nt
    v_cmp_ge_u32 s[90:91], v205, v209
    v_cmp_gt_u32 s[92:93], v205, v209
    s_bcnt1_i32_b32 s51, s90
    s_bcnt1_i32_b32 s94, s92
    s_add_u32 s51, s51, s94
    s_mov_b32 s94, 1
    s_cmp_ge_u32 s51, 31
    s_cselect_b32 s51, 3, s94
    v_mov_b32 v205, s51
    ds_write_b32 v206, v205 offset:19328
    s_sub_u32 s51, s53, 2
    s_and_b32 s51, s51, 0xfffffff9
    s_cbranch_scc0 L_conv3
L_conv3_back:
    s_waitcnt vmcnt(9)
    s_cbranch_vccnz L_dwV14
    s_waitcnt vmcnt(6)
L_dwV14:
    s_xor_b32 s46, s46, 4096
    buffer_load_dwordx4 v[124:127], v4, s[24:27], s46 offen offset:0 nt
    ds_read_b32 v18, v6
    ds_read_b128 v[48:51], v23
    v_add_u32 v6, 544, v6
    v_add_u32 v23, 544, v23
    s_waitcnt vmcnt(9)
    s_cbranch_vccnz L_dwV15
    s_waitcnt vmcnt(6)
L_dwV15:
    buffer_load_dwordx4 v[128:131], v4, s[24:27], s46 offen offset:1024 nt
    s_waitcnt lgkmcnt(0)
    v_mul_f32 v60, v60, v18
    v_mul_f32 v61, v61, v18
    v_mul_f32 v62, v62, v18
    v_mul_f32 v63, v63, v18
    v_mul_f32 v64, v64, v18
    v_mul_f32 v65, v65, v18
    v_mul_f32 v66, v66, v18
    v_mul_f32 v67, v67, v18
    v_mul_f32 v68, v68, v18
    v_mul_f32 v69, v69, v18
    v_mul_f32 v70, v70, v18
    v_mul_f32 v71, v71, v18
    v_mul_f32 v72, v72, v18
    v_mul_f32 v73, v73, v18
    v_mul_f32 v74, v74, v18
    v_mul_f32 v75, v75, v18
    v_mul_f32 v76, v76, v18
    v_mul_f32 v77, v77, v18
    v_mul_f32 v78, v78, v18
    v_mul_f32 v79, v79, v18
    v_mul_f32 v80, v80, v18
    v_mul_f32 v81, v81, v18
    v_mul_f32 v82, v82, v18
    v_mul_f32 v83, v83, v18
    v_mul_f32 v84, v84, v18
    v_mul_f32 v85, v85, v18
    v_mul_f32 v86, v86, v18
    v_mul_f32 v87, v87, v18
    v_mul_f32 v88, v88, v18
    v_mul_f32 v89, v89, v18
    v_mul_f32 v90, v90, v18
    v_mul_f32 v91, v91, v18
    s_waitcnt vmcnt(9)
    s_cbranch_vccnz L_dwV16
    s_waitcnt vmcnt(6)
L_dwV16:
    buffer_load_dwordx4 v[132:135], v4, s[24:27], s46 offen offset:2048 nt
    s_waitcnt vmcnt(9)
    s_cbranch_vccnz L_dwV17
    s_waitcnt vmcnt(4)
L_dwV17:
    buffer_load_dwordx4 v[136:139], v4, s[24:27], s46 offen offset:3072 nt
    v_perm_b32 v52, v144, v140, s48
    v_perm_b32 v53, v152, v148, s48
    v_perm_b32 v54, v160, v156, s48
    v_perm_b32 v55, v168, v164, s48
    v_perm_b32 v56, v144, v140, s49
    v_perm_b32 v57, v152, v148, s49
    v_perm_b32 v58, v160, v156, s49
    v_perm_b32 v59, v168, v164, s49
    v_mfma_f32_16x16x32_bf16 v[60:63], v[52:55], v[48:51], v[60:63]
    v_perm_b32 v52, v145, v141, s48
    v_perm_b32 v53, v153, v149, s48
    v_perm_b32 v54, v161, v157, s48
    v_perm_b32 v55, v169, v165, s48
    v_mfma_f32_16x16x32_bf16 v[64:67], v[56:59], v[48:51], v[64:67]
    v_perm_b32 v56, v145, v141, s49
    v_perm_b32 v57, v153, v149, s49
    v_perm_b32 v58, v161, v157, s49
    v_perm_b32 v59, v169, v165, s49
    v_mfma_f32_16x16x32_bf16 v[68:71], v[52:55], v[48:51], v[68:71]
    v_perm_b32 v52, v146, v142, s48
    v_perm_b32 v53, v154, v150, s48
    v_perm_b32 v54, v162, v158, s48
    v_perm_b32 v55, v170, v166, s48
    v_mfma_f32_16x16x32_bf16 v[72:75], v[56:59], v[48:51], v[72:75]
    v_perm_b32 v56, v146, v142, s49
    v_perm_b32 v57, v154, v150, s49
    v_perm_b32 v58, v162, v158, s49
    v_perm_b32 v59, v170, v166, s49
    v_mfma_f32_16x16x32_bf16 v[76:79], v[52:55], v[48:51], v[76:79]
    v_perm_b32 v52, v147, v143, s48
    v_perm_b32 v53, v155, v151, s48
    v_perm_b32 v54, v163, v159, s48
    v_perm_b32 v55, v171, v167, s48
    v_mfma_f32_16x16x32_bf16 v[80:83], v[56:59], v[48:51], v[80:83]
    v_perm_b32 v56, v147, v143, s49
    v_perm_b32 v57, v155, v151, s49
    v_perm_b32 v58, v163, v159, s49
    v_perm_b32 v59, v171, v167, s49
    v_mfma_f32_16x16x32_bf16 v[84:87], v[52:55], v[48:51], v[84:87]
    s_nop 1
    v_mfma_f32_16x16x32_bf16 v[88:91], v[56:59], v[48:51], v[88:91]
    s_waitcnt vmcnt(9)
    s_cbranch_vccnz L_dwV18
    s_waitcnt vmcnt(4)
L_dwV18:
    s_barrier
    s_mov_b32 s46, s45
    s_add_u32 s45, s46, 0x10000
    buffer_load_dwordx4 v[140:143], v4, s[24:27], s46 offen offset:0 nt
    s_waitcnt vmcnt(9)
    s_cbranch_vccnz L_dwV19
    s_waitcnt vmcnt(4)
L_dwV19:
    buffer_load_dwordx4 v[144:147], v4, s[24:27], s46 offen offset:1024 nt
    s_lshr_b32 s51, s55, 2
    s_and_b32 s51, s51, 0x3800
    s_add_u32 s51, s51, s63
    s_cmp_lt_u32 s55, 0x20000
    s_cselect_b32 m0, s51, 19456
    s_nop 0
    buffer_load_dwordx4 v7, s[36:39], s55 offen offset:0 nt lds
    buffer_load_dwordx4 v7, s[36:39], s55 offen offset:1024 nt lds
    s_add_u32 s55, s55, 8192
    s_waitcnt vmcnt(9)
    s_cbranch_vccnz L_dwV110
    s_waitcnt vmcnt(6)
L_dwV110:
    buffer_load_dwordx4 v[148:151], v4, s[24:27], s46 offen offset:2048 nt
    v_add_u32 v209, 1, v209
    buffer_load_ubyte v205, v208, s[84:87], 0 offen sc0
    s_mov_b64 exec, 1
    buffer_store_byte v209, v204, s[84:87], 0 offen
    s_mov_b64 exec, -1
    s_waitcnt vmcnt(10)
    s_cbranch_vccnz L_dwV111
    s_waitcnt vmcnt(8)
L_dwV111:
    buffer_load_dwordx4 v[152:155], v4, s[24:27], s46 offen offset:3072 nt
    v_mov_b32 v207, 0
    ds_read_b32 v207, v207 offset:19328
    s_sub_u32 s51, s53, 2
    s_and_b32 s51, s51, 0xfffffff9
    s_cbranch_scc0 L_conv11
L_conv11_back:
    s_waitcnt vmcnt(10)
    s_cbranch_vccnz L_dwV112
    s_waitcnt vmcnt(8)
L_dwV112:
    s_xor_b32 s46, s46, 4096
    buffer_load_dwordx4 v[156:159], v4, s[24:27], s46 offen offset:0 nt
    ds_read_b32 v18, v6
    ds_read_b128 v[48:51], v23
    v_add_u32 v6, 544, v6
    v_add_u32 v23, 544, v23
    s_waitcnt vmcnt(10)
    s_cbranch_vccnz L_dwV113
    s_waitcnt vmcnt(8)
L_dwV113:
    buffer_load_dwordx4 v[160:163], v4, s[24:27], s46 offen offset:1024 nt
    s_waitcnt lgkmcnt(0)
    v_mul_f32 v60, v60, v18
    v_mul_f32 v61, v61, v18
    v_mul_f32 v62, v62, v18
    v_mul_f32 v63, v63, v18
    v_mul_f32 v64, v64, v18
    v_mul_f32 v65, v65, v18
    v_mul_f32 v66, v66, v18
    v_mul_f32 v67, v67, v18
    v_mul_f32 v68, v68, v18
    v_mul_f32 v69, v69, v18
    v_mul_f32 v70, v70, v18
    v_mul_f32 v71, v71, v18
    v_mul_f32 v72, v72, v18
    v_mul_f32 v73, v73, v18
    v_mul_f32 v74, v74, v18
    v_mul_f32 v75, v75, v18
    v_mul_f32 v76, v76, v18
    v_mul_f32 v77, v77, v18
    v_mul_f32 v78, v78, v18
    v_mul_f32 v79, v79, v18
    v_mul_f32 v80, v80, v18
    v_mul_f32 v81, v81, v18
    v_mul_f32 v82, v82, v18
    v_mul_f32 v83, v83, v18
    v_mul_f32 v84, v84, v18
    v_mul_f32 v85, v85, v18
    v_mul_f32 v86, v86, v18
    v_mul_f32 v87, v87, v18
    v_mul_f32 v88, v88, v18
    v_mul_f32 v89, v89, v18
    v_mul_f32 v90, v90, v18
    v_mul_f32 v91, v91, v18
    s_waitcnt vmcnt(10)
    s_cbranch_vccnz L_dwV114
    s_waitcnt vmcnt(8)
L_dwV114:
    buffer_load_dwordx4 v[164:167], v4, s[24:27], s46 offen offset:2048 nt
    v_readfirstlane_b32 s51, v207
    s_mov_b32 s58, s51
    s_cmp_ge_u32 s51, 3
    s_cselect_b64 vcc, -1, 0
    s_waitcnt vmcnt(10)
    s_cbranch_vccnz L_dwV115
    s_waitcnt vmcnt(6)
L_dwV115:
    buffer_load_dwordx4 v[168:171], v4, s[24:27], s46 offen offset:3072 nt
    v_perm_b32 v52, v112, v108, s48
    v_perm_b32 v53, v120, v116, s48
    v_perm_b32 v54, v128, v124, s48
    v_perm_b32 v55, v136, v132, s48
    v_perm_b32 v56, v112, v108, s49
    v_perm_b32 v57, v120, v116, s49
    v_perm_b32 v58, v128, v124, s49
    v_perm_b32 v59, v136, v132, s49
    v_mfma_f32_16x16x32_bf16 v[60:63], v[52:55], v[48:51], v[60:63]
    v_perm_b32 v52, v113, v109, s48
    v_perm_b32 v53, v121, v117, s48
    v_perm_b32 v54, v129, v125, s48
    v_perm_b32 v55, v137, v133, s48
    v_mfma_f32_16x16x32_bf16 v[64:67], v[56:59], v[48:51], v[64:67]
    v_perm_b32 v56, v113, v109, s49
    v_perm_b32 v57, v121, v117, s49
    v_perm_b32 v58, v129, v125, s49
    v_perm_b32 v59, v137, v133, s49
    v_mfma_f32_16x16x32_bf16 v[68:71], v[52:55], v[48:51], v[68:71]
    v_perm_b32 v52, v114, v110, s48
    v_perm_b32 v53, v122, v118, s48
    v_perm_b32 v54, v130, v126, s48
    v_perm_b32 v55, v138, v134, s48
    v_mfma_f32_16x16x32_bf16 v[72:75], v[56:59], v[48:51], v[72:75]
    v_perm_b32 v56, v114, v110, s49
    v_perm_b32 v57, v122, v118, s49
    v_perm_b32 v58, v130, v126, s49
    v_perm_b32 v59, v138, v134, s49
    v_mfma_f32_16x16x32_bf16 v[76:79], v[52:55], v[48:51], v[76:79]
    v_perm_b32 v52, v115, v111, s48
    v_perm_b32 v53, v123, v119, s48
    v_perm_b32 v54, v131, v127, s48
    v_perm_b32 v55, v139, v135, s48
    v_mfma_f32_16x16x32_bf16 v[80:83], v[56:59], v[48:51], v[80:83]
    v_perm_b32 v56, v115, v111, s49
    v_perm_b32 v57, v123, v119, s49
    v_perm_b32 v58, v131, v127, s49
    v_perm_b32 v59, v139, v135, s49
    v_mfma_f32_16x16x32_bf16 v[84:87], v[52:55], v[48:51], v[84:87]
    s_nop 1
    v_mfma_f32_16x16x32_bf16 v[88:91], v[56:59], v[48:51], v[88:91]
    s_add_u32 s53, s53, 1
    s_cmp_lt_u32 s53, 13
    s_cbranch_scc1 L_loopV
L_loopV2:
    s_waitcnt vmcnt(7)
    s_barrier
    s_mov_b32 s46, s44
    s_add_u32 s44, s46, 0x10000
    buffer_load_dwordx4 v[108:111], v4, s[24:27], s46 offen offset:0 nt
    s_waitcnt vmcnt(7)
    buffer_load_dwordx4 v[112:115], v4, s[24:27], s46 offen offset:1024 nt
    s_waitcnt vmcnt(7)
    buffer_load_dwordx4 v[116:119], v4, s[24:27], s46 offen offset:2048 nt
    s_waitcnt vmcnt(7)
    buffer_load_dwordx4 v[120:123], v4, s[24:27], s46 offen offset:3072 nt
    s_waitcnt vmcnt(7)
    s_xor_b32 s46, s46, 4096
    buffer_load_dwordx4 v[124:127], v4, s[24:27], s46 offen offset:0 nt
    ds_read_b32 v18, v6
    ds_read_b128 v[48:51], v23
    v_add_u32 v6, 544, v6
    v_add_u32 v23, 544, v23
    s_waitcnt vmcnt(7)
    buffer_load_dwordx4 v[128:131], v4, s[24:27], s46 offen offset:1024 nt
    s_waitcnt lgkmcnt(0)
    v_mul_f32 v60, v60, v18
    v_mul_f32 v61, v61, v18
    v_mul_f32 v62, v62, v18
    v_mul_f32 v63, v63, v18
    v_mul_f32 v64, v64, v18
    v_mul_f32 v65, v65, v18
    v_mul_f32 v66, v66, v18
    v_mul_f32 v67, v67, v18
    v_mul_f32 v68, v68, v18
    v_mul_f32 v69, v69, v18
    v_mul_f32 v70, v70, v18
    v_mul_f32 v71, v71, v18
    v_mul_f32 v72, v72, v18
    v_mul_f32 v73, v73, v18
    v_mul_f32 v74, v74, v18
    v_mul_f32 v75, v75, v18
    v_mul_f32 v76, v76, v18
    v_mul_f32 v77, v77, v18
    v_mul_f32 v78, v78, v18
    v_mul_f32 v79, v79, v18
    v_mul_f32 v80, v80, v18
    v_mul_f32 v81, v81, v18
    v_mul_f32 v82, v82, v18
    v_mul_f32 v83, v83, v18
    v_mul_f32 v84, v84, v18
    v_mul_f32 v85, v85, v18
    v_mul_f32 v86, v86, v18
    v_mul_f32 v87, v87, v18
    v_mul_f32 v88, v88, v18
    v_mul_f32 v89, v89, v18
    v_mul_f32 v90, v90, v18
    v_mul_f32 v91, v91, v18
    s_waitcnt vmcnt(7)
    buffer_load_dwordx4 v[132:135], v4, s[24:27], s46 offen offset:2048 nt
    s_waitcnt vmcnt(7)
    buffer_load_dwordx4 v[136:139], v4, s[24:27], s46 offen offset:3072 nt
    v_perm_b32 v52, v144, v140, s48
    v_perm_b32 v53, v152, v148, s48
    v_perm_b32 v54, v160, v156, s48
    v_perm_b32 v55, v168, v164, s48
    v_perm_b32 v56, v144, v140, s49
    v_perm_b32 v57, v152, v148, s49
    v_perm_b32 v58, v160, v156, s49
    v_perm_b32 v59, v168, v164, s49
    v_mfma_f32_16x16x32_bf16 v[60:63], v[52:55], v[48:51], v[60:63]
    v_perm_b32 v52, v145, v141, s48
    v_perm_b32 v53, v153, v149, s48
    v_perm_b32 v54, v161, v157, s48
    v_perm_b32 v55, v169, v165, s48
    v_mfma_f32_16x16x32_bf16 v[64:67], v[56:59], v[48:51], v[64:67]
    v_perm_b32 v56, v145, v141, s49
    v_perm_b32 v57, v153, v149, s49
    v_perm_b32 v58, v161, v157, s49
    v_perm_b32 v59, v169, v165, s49
    v_mfma_f32_16x16x32_bf16 v[68:71], v[52:55], v[48:51], v[68:71]
    v_perm_b32 v52, v146, v142, s48
    v_perm_b32 v53, v154, v150, s48
    v_perm_b32 v54, v162, v158, s48
    v_perm_b32 v55, v170, v166, s48
    v_mfma_f32_16x16x32_bf16 v[72:75], v[56:59], v[48:51], v[72:75]
    v_perm_b32 v56, v146, v142, s49
    v_perm_b32 v57, v154, v150, s49
    v_perm_b32 v58, v162, v158, s49
    v_perm_b32 v59, v170, v166, s49
    v_mfma_f32_16x16x32_bf16 v[76:79], v[52:55], v[48:51], v[76:79]
    v_perm_b32 v52, v147, v143, s48
    v_perm_b32 v53, v155, v151, s48
    v_perm_b32 v54, v163, v159, s48
    v_perm_b32 v55, v171, v167, s48
    v_mfma_f32_16x16x32_bf16 v[80:83], v[56:59], v[48:51], v[80:83]
    v_perm_b32 v56, v147, v143, s49
    v_perm_b32 v57, v155, v151, s49
    v_perm_b32 v58, v163, v159, s49
    v_perm_b32 v59, v171, v167, s49
    v_mfma_f32_16x16x32_bf16 v[84:87], v[52:55], v[48:51], v[84:87]
    s_nop 1
    v_mfma_f32_16x16x32_bf16 v[88:91], v[56:59], v[48:51], v[88:91]
    s_waitcnt vmcnt(7)
    s_barrier
    s_mov_b32 s46, s45
    s_add_u32 s45, s46, 0x10000
    buffer_load_dwordx4 v[140:143], v4, s[24:27], s46 offen offset:0 nt
    s_waitcnt vmcnt(7)
    buffer_load_dwordx4 v[144:147], v4, s[24:27], s46 offen offset:1024 nt
    s_waitcnt vmcnt(7)
    buffer_load_dwordx4 v[148:151], v4, s[24:27], s46 offen offset:2048 nt
    s_waitcnt vmcnt(7)
    buffer_load_dwordx4 v[152:155], v4, s[24:27], s46 offen offset:3072 nt
    s_waitcnt vmcnt(7)
    s_xor_b32 s46, s46, 4096
    buffer_load_dwordx4 v[156:159], v4, s[24:27], s46 offen offset:0 nt
    ds_read_b32 v18, v6
    ds_read_b128 v[48:51], v23
    v_add_u32 v6, 544, v6
    v_add_u32 v23, 544, v23
    s_waitcnt vmcnt(7)
    buffer_load_dwordx4 v[160:163], v4, s[24:27], s46 offen offset:1024 nt
    s_waitcnt lgkmcnt(0)
    v_mul_f32 v60, v60, v18
    v_mul_f32 v61, v61, v18
    v_mul_f32 v62, v62, v18
    v_mul_f32 v63, v63, v18
    v_mul_f32 v64, v64, v18
    v_mul_f32 v65, v65, v18
    v_mul_f32 v66, v66, v18
    v_mul_f32 v67, v67, v18
    v_mul_f32 v68, v68, v18
    v_mul_f32 v69, v69, v18
    v_mul_f32 v70, v70, v18
    v_mul_f32 v71, v71, v18
    v_mul_f32 v72, v72, v18
    v_mul_f32 v73, v73, v18
    v_mul_f32 v74, v74, v18
    v_mul_f32 v75, v75, v18
    v_mul_f32 v76, v76, v18
    v_mul_f32 v77, v77, v18
    v_mul_f32 v78, v78, v18
    v_mul_f32 v79, v79, v18
    v_mul_f32 v80, v80, v18
    v_mul_f32 v81, v81, v18
    v_mul_f32 v82, v82, v18
    v_mul_f32 v83, v83, v18
    v_mul_f32 v84, v84, v18
    v_mul_f32 v85, v85, v18
    v_mul_f32 v86, v86, v18
    v_mul_f32 v87, v87, v18
    v_mul_f32 v88, v88, v18
    v_mul_f32 v89, v89, v18
    v_mul_f32 v90, v90, v18
    v_mul_f32 v91, v91, v18
    s_waitcnt vmcnt(7)
    buffer_load_dwordx4 v[164:167], v4, s[24:27], s46 offen offset:2048 nt
    s_waitcnt vmcnt(7)
    buffer_load_dwordx4 v[168:171], v4, s[24:27], s46 offen offset:3072 nt
    v_perm_b32 v52, v112, v108, s48
    v_perm_b32 v53, v120, v116, s48
    v_perm_b32 v54, v128, v124, s48
    v_perm_b32 v55, v136, v132, s48
    v_perm_b32 v56, v112, v108, s49
    v_perm_b32 v57, v120, v116, s49
    v_perm_b32 v58, v128, v124, s49
    v_perm_b32 v59, v136, v132, s49
    v_mfma_f32_16x16x32_bf16 v[60:63], v[52:55], v[48:51], v[60:63]
    v_perm_b32 v52, v113, v109, s48
    v_perm_b32 v53, v121, v117, s48
    v_perm_b32 v54, v129, v125, s48
    v_perm_b32 v55, v137, v133, s48
    v_mfma_f32_16x16x32_bf16 v[64:67], v[56:59], v[48:51], v[64:67]
    v_perm_b32 v56, v113, v109, s49
    v_perm_b32 v57, v121, v117, s49
    v_perm_b32 v58, v129, v125, s49
    v_perm_b32 v59, v137, v133, s49
    v_mfma_f32_16x16x32_bf16 v[68:71], v[52:55], v[48:51], v[68:71]
    v_perm_b32 v52, v114, v110, s48
    v_perm_b32 v53, v122, v118, s48
    v_perm_b32 v54, v130, v126, s48
    v_perm_b32 v55, v138, v134, s48
    v_mfma_f32_16x16x32_bf16 v[72:75], v[56:59], v[48:51], v[72:75]
    v_perm_b32 v56, v114, v110, s49
    v_perm_b32 v57, v122, v118, s49
    v_perm_b32 v58, v130, v126, s49
    v_perm_b32 v59, v138, v134, s49
    v_mfma_f32_16x16x32_bf16 v[76:79], v[52:55], v[48:51], v[76:79]
    v_perm_b32 v52, v115, v111, s48
    v_perm_b32 v53, v123, v119, s48
    v_perm_b32 v54, v131, v127, s48
    v_perm_b32 v55, v139, v135, s48
    v_mfma_f32_16x16x32_bf16 v[80:83], v[56:59], v[48:51], v[80:83]
    v_perm_b32 v56, v115, v111, s49
    v_perm_b32 v57, v123, v119, s49
    v_perm_b32 v58, v131, v127, s49
    v_perm_b32 v59, v139, v135, s49
    v_mfma_f32_16x16x32_bf16 v[84:87], v[52:55], v[48:51], v[84:87]
    s_nop 1
    v_mfma_f32_16x16x32_bf16 v[88:91], v[56:59], v[48:51], v[88:91]
    s_add_u32 s53, s53, 1
    s_cmp_lt_u32 s53, 15
    s_cbranch_scc1 L_loopV2
    ds_read_b32 v18, v6
    ds_read_b128 v[48:51], v23
    v_add_u32 v6, 544, v6
    v_add_u32 v23, 544, v23
    s_waitcnt lgkmcnt(0)
    v_mul_f32 v60, v60, v18
    v_mul_f32 v61, v61, v18
    v_mul_f32 v62, v62, v18
    v_mul_f32 v63, v63, v18
    v_mul_f32 v64, v64, v18
    v_mul_f32 v65, v65, v18
    v_mul_f32 v66, v66, v18
    v_mul_f32 v67, v67, v18
    v_mul_f32 v68, v68, v18
    v_mul_f32 v69, v69, v18
    v_mul_f32 v70, v70, v18
    v_mul_f32 v71, v71, v18
    v_mul_f32 v72, v72, v18
    v_mul_f32 v73, v73, v18
    v_mul_f32 v74, v74, v18
    v_mul_f32 v75, v75, v18
    v_mul_f32 v76, v76, v18
    v_mul_f32 v77, v77, v18
    v_mul_f32 v78, v78, v18
    v_mul_f32 v79, v79, v18
    v_mul_f32 v80, v80, v18
    v_mul_f32 v81, v81, v18
    v_mul_f32 v82, v82, v18
    v_mul_f32 v83, v83, v18
    v_mul_f32 v84, v84, v18
    v_mul_f32 v85, v85, v18
    v_mul_f32 v86, v86, v18
    v_mul_f32 v87, v87, v18
    v_mul_f32 v88, v88, v18
    v_mul_f32 v89, v89, v18
    v_mul_f32 v90, v90, v18
    v_mul_f32 v91, v91, v18
    s_waitcnt vmcnt(0)
    v_perm_b32 v52, v144, v140, s48
    v_perm_b32 v53, v152, v148, s48
    v_perm_b32 v54, v160, v156, s48
    v_perm_b32 v55, v168, v164, s48
    v_perm_b32 v56, v144, v140, s49
    v_perm_b32 v57, v152, v148, s49
    v_perm_b32 v58, v160, v156, s49
    v_perm_b32 v59, v168, v164, s49
    v_mfma_f32_16x16x32_bf16 v[60:63], v[52:55], v[48:51], v[60:63]
    v_perm_b32 v52, v145, v141, s48
    v_perm_b32 v53, v153, v149, s48
    v_perm_b32 v54, v161, v157, s48
    v_perm_b32 v55, v169, v165, s48
    v_mfma_f32_16x16x32_bf16 v[64:67], v[56:59], v[48:51], v[64:67]
    v_perm_b32 v56, v145, v141, s49
    v_perm_b32 v57, v153, v149, s49
    v_perm_b32 v58, v161, v157, s49
    v_perm_b32 v59, v169, v165, s49
    v_mfma_f32_16x16x32_bf16 v[68:71], v[52:55], v[48:51], v[68:71]
    ds_write_b128 v22, v[60:63] offset:0
    v_perm_b32 v52, v146, v142, s48
    v_perm_b32 v53, v154, v150, s48
    v_perm_b32 v54, v162, v158, s48
    v_perm_b32 v55, v170, v166, s48
    v_mfma_f32_16x16x32_bf16 v[72:75], v[56:59], v[48:51], v[72:75]
    ds_write_b128 v22, v[64:67] offset:16
    v_perm_b32 v56, v146, v142, s49
    v_perm_b32 v57, v154, v150, s49
    v_perm_b32 v58, v162, v158, s49
    v_perm_b32 v59, v170, v166, s49
    v_mfma_f32_16x16x32_bf16 v[76:79], v[52:55], v[48:51], v[76:79]
    ds_write_b128 v22, v[68:71] offset:32
    v_perm_b32 v52, v147, v143, s48
    v_perm_b32 v53, v155, v151, s48
    v_perm_b32 v54, v163, v159, s48
    v_perm_b32 v55, v171, v167, s48
    v_mfma_f32_16x16x32_bf16 v[80:83], v[56:59], v[48:51], v[80:83]
    ds_write_b128 v22, v[72:75] offset:48
    v_perm_b32 v56, v147, v143, s49
    v_perm_b32 v57, v155, v151, s49
    v_perm_b32 v58, v163, v159, s49
    v_perm_b32 v59, v171, v167, s49
    v_mfma_f32_16x16x32_bf16 v[84:87], v[52:55], v[48:51], v[84:87]
    ds_write_b128 v22, v[76:79] offset:64
    s_nop 1
    v_mfma_f32_16x16x32_bf16 v[88:91], v[56:59], v[48:51], v[88:91]
    ds_write_b128 v22, v[80:83] offset:80
    s_nop 3
    ds_write_b128 v22, v[84:87] offset:96
    s_nop 1
    ds_write_b128 v22, v[88:91] offset:112
    s_waitcnt lgkmcnt(0)
    s_barrier
    ds_read_b128 v[32:35], v28 offset:0
    ds_read_b128 v[36:39], v28 offset:4224
    ds_read_b128 v[40:43], v28 offset:8448
    ds_read_b128 v[44:47], v28 offset:12672
    s_waitcnt lgkmcnt(3)
    v_mul_f32 v32, v32, v24
    v_mul_f32 v33, v33, v24
    v_mul_f32 v34, v34, v24
    v_mul_f32 v35, v35, v24
    s_waitcnt lgkmcnt(2)
    v_fmac_f32 v32, v36, v25
    v_fmac_f32 v33, v37, v25
    v_fmac_f32 v34, v38, v25
    v_fmac_f32 v35, v39, v25
    s_waitcnt lgkmcnt(1)
    v_fmac_f32 v32, v40, v26
    v_fmac_f32 v33, v41, v26
    v_fmac_f32 v34, v42, v26
    v_fmac_f32 v35, v43, v26
    s_waitcnt lgkmcnt(0)
    v_fmac_f32 v32, v44, v27
    v_fmac_f32 v33, v45, v27
    v_fmac_f32 v34, v46, v27
    v_fmac_f32 v35, v47, v27
    v_cvt_pk_bf16_f32 v48, v32, v33
    v_cvt_pk_bf16_f32 v49, v34, v35
    ds_write_b64 v29, v[48:49] offset:16896
    s_waitcnt lgkmcnt(0)
    s_barrier
    ds_read_b128 v[92:95], v15 offset:16896
    ds_read_b128 v[96:99], v15 offset:16960
    ds_read_b128 v[100:103], v15 offset:17024
    ds_read_b128 v[104:107], v15 offset:17088
    s_waitcnt lgkmcnt(3)
    v_mfma_f32_16x16x32_bf16 v[60:63], a[0:3], v[92:95], 0
    s_waitcnt lgkmcnt(2)
    v_mfma_f32_16x16x32_bf16 v[60:63], a[32:35], v[96:99], v[60:63]
    s_waitcnt lgkmcnt(1)
    v_mfma_f32_16x16x32_bf16 v[60:63], a[64:67], v[100:103], v[60:63]
    s_waitcnt lgkmcnt(0)
    v_mfma_f32_16x16x32_bf16 v[60:63], a[96:99], v[104:107], v[60:63]
    v_mfma_f32_16x16x32_bf16 v[64:67], a[4:7], v[92:95], 0
    v_mfma_f32_16x16x32_bf16 v[64:67], a[36:39], v[96:99], v[64:67]
    v_mfma_f32_16x16x32_bf16 v[64:67], a[68:71], v[100:103], v[64:67]
    v_mfma_f32_16x16x32_bf16 v[64:67], a[100:103], v[104:107], v[64:67]
    v_mfma_f32_16x16x32_bf16 v[68:71], a[8:11], v[92:95], 0
    v_mfma_f32_16x16x32_bf16 v[68:71], a[40:43], v[96:99], v[68:71]
    v_mfma_f32_16x16x32_bf16 v[68:71], a[72:75], v[100:103], v[68:71]
    v_mfma_f32_16x16x32_bf16 v[68:71], a[104:107], v[104:107], v[68:71]
    buffer_store_dwordx4 v[60:63], v30, s[40:43], s62 offen offset:0
    v_mfma_f32_16x16x32_bf16 v[72:75], a[12:15], v[92:95], 0
    v_mfma_f32_16x16x32_bf16 v[72:75], a[44:47], v[96:99], v[72:75]
    v_mfma_f32_16x16x32_bf16 v[72:75], a[76:79], v[100:103], v[72:75]
    v_mfma_f32_16x16x32_bf16 v[72:75], a[108:111], v[104:107], v[72:75]
    buffer_store_dwordx4 v[64:67], v30, s[40:43], s62 offen offset:128
    v_mfma_f32_16x16x32_bf16 v[76:79], a[16:19], v[92:95], 0
    v_mfma_f32_16x16x32_bf16 v[76:79], a[48:51], v[96:99], v[76:79]
    v_mfma_f32_16x16x32_bf16 v[76:79], a[80:83], v[100:103], v[76:79]
    v_mfma_f32_16x16x32_bf16 v[76:79], a[112:115], v[104:107], v[76:79]
    buffer_store_dwordx4 v[68:71], v30, s[40:43], s62 offen offset:256
    v_mfma_f32_16x16x32_bf16 v[80:83], a[20:23], v[92:95], 0
    v_mfma_f32_16x16x32_bf16 v[80:83], a[52:55], v[96:99], v[80:83]
    v_mfma_f32_16x16x32_bf16 v[80:83], a[84:87], v[100:103], v[80:83]
    v_mfma_f32_16x16x32_bf16 v[80:83], a[116:119], v[104:107], v[80:83]
    buffer_store_dwordx4 v[72:75], v30, s[40:43], s62 offen offset:384
    v_mfma_f32_16x16x32_bf16 v[84:87], a[24:27], v[92:95], 0
    v_mfma_f32_16x16x32_bf16 v[84:87], a[56:59], v[96:99], v[84:87]
    v_mfma_f32_16x16x32_bf16 v[84:87], a[88:91], v[100:103], v[84:87]
    v_mfma_f32_16x16x32_bf16 v[84:87], a[120:123], v[104:107], v[84:87]
    buffer_store_dwordx4 v[76:79], v30, s[40:43], s62 offen offset:512
    v_mfma_f32_16x16x32_bf16 v[88:91], a[28:31], v[92:95], 0
    v_mfma_f32_16x16x32_bf16 v[88:91], a[60:63], v[96:99], v[88:91]
    v_mfma_f32_16x16x32_bf16 v[88:91], a[92:95], v[100:103], v[88:91]
    v_mfma_f32_16x16x32_bf16 v[88:91], a[124:127], v[104:107], v[88:91]
    buffer_store_dwordx4 v[80:83], v30, s[40:43], s62 offen offset:640
    s_nop 1
    buffer_store_dwordx4 v[84:87], v30, s[40:43], s62 offen offset:768
    s_nop 3
    buffer_store_dwordx4 v[88:91], v30, s[40:43], s62 offen offset:896
    s_mov_b32 s2, -1
    s_branch mha_reduce_kernel
L_main_end:
    s_endpgm
L_conv3:
    s_cmp_eq_u32 s53, 2
    s_cbranch_scc1 L_conv3_2
    s_cmp_eq_u32 s53, 4
    s_cbranch_scc1 L_conv3_4
    s_cmp_eq_u32 s53, 6
    s_cbranch_scc1 L_conv3_6
    s_cmp_eq_u32 s53, 8
    s_cbranch_scc1 L_conv3_8
    s_branch L_conv3_back
L_conv3_2:
    ds_read_b128 v[172:175], v5 offset:0
    ds_read_b128 v[176:179], v5 offset:2048
    ds_read_b128 v[180:183], v5 offset:4096
    ds_read_b128 v[184:187], v5 offset:6144
    ds_read_b128 v[188:191], v5 offset:1024
    ds_read_b128 v[192:195], v5 offset:3072
    ds_read_b128 v[196:199], v5 offset:5120
    ds_read_b128 v[200:203], v5 offset:7168
    s_waitcnt lgkmcnt(0)
    v_perm_b32 v52, v176, v172, s48
    v_perm_b32 v53, v184, v180, s48
    v_perm_b32 v54, v192, v188, s48
    v_perm_b32 v55, v200, v196, s48
    v_accvgpr_write_b32 a0, v52
    v_accvgpr_write_b32 a1, v53
    v_accvgpr_write_b32 a2, v54
    v_accvgpr_write_b32 a3, v55
    v_perm_b32 v56, v176, v172, s49
    v_perm_b32 v57, v184, v180, s49
    v_perm_b32 v58, v192, v188, s49
    v_perm_b32 v59, v200, v196, s49
    v_accvgpr_write_b32 a4, v56
    v_accvgpr_write_b32 a5, v57
    v_accvgpr_write_b32 a6, v58
    v_accvgpr_write_b32 a7, v59
    v_perm_b32 v52, v177, v173, s48
    v_perm_b32 v53, v185, v181, s48
    v_perm_b32 v54, v193, v189, s48
    v_perm_b32 v55, v201, v197, s48
    v_accvgpr_write_b32 a8, v52
    v_accvgpr_write_b32 a9, v53
    v_accvgpr_write_b32 a10, v54
    v_accvgpr_write_b32 a11, v55
    v_perm_b32 v56, v177, v173, s49
    v_perm_b32 v57, v185, v181, s49
    v_perm_b32 v58, v193, v189, s49
    v_perm_b32 v59, v201, v197, s49
    v_accvgpr_write_b32 a12, v56
    v_accvgpr_write_b32 a13, v57
    v_accvgpr_write_b32 a14, v58
    v_accvgpr_write_b32 a15, v59
    s_branch L_conv3_back
L_conv3_4:
    ds_read_b128 v[172:175], v5 offset:8192
    ds_read_b128 v[176:179], v5 offset:10240
    ds_read_b128 v[180:183], v5 offset:12288
    ds_read_b128 v[184:187], v5 offset:14336
    ds_read_b128 v[188:191], v5 offset:9216
    ds_read_b128 v[192:195], v5 offset:11264
    ds_read_b128 v[196:199], v5 offset:13312
    ds_read_b128 v[200:203], v5 offset:15360
    s_waitcnt lgkmcnt(0)
    v_perm_b32 v52, v176, v172, s48
    v_perm_b32 v53, v184, v180, s48
    v_perm_b32 v54, v192, v188, s48
    v_perm_b32 v55, v200, v196, s48
    v_accvgpr_write_b32 a32, v52
    v_accvgpr_write_b32 a33, v53
    v_accvgpr_write_b32 a34, v54
    v_accvgpr_write_b32 a35, v55
    v_perm_b32 v56, v176, v172, s49
    v_perm_b32 v57, v184, v180, s49
    v_perm_b32 v58, v192, v188, s49
    v_perm_b32 v59, v200, v196, s49
    v_accvgpr_write_b32 a36, v56
    v_accvgpr_write_b32 a37, v57
    v_accvgpr_write_b32 a38, v58
    v_accvgpr_write_b32 a39, v59
    v_perm_b32 v52, v177, v173, s48
    v_perm_b32 v53, v185, v181, s48
    v_perm_b32 v54, v193, v189, s48
    v_perm_b32 v55, v201, v197, s48
    v_accvgpr_write_b32 a40, v52
    v_accvgpr_write_b32 a41, v53
    v_accvgpr_write_b32 a42, v54
    v_accvgpr_write_b32 a43, v55
    v_perm_b32 v56, v177, v173, s49
    v_perm_b32 v57, v185, v181, s49
    v_perm_b32 v58, v193, v189, s49
    v_perm_b32 v59, v201, v197, s49
    v_accvgpr_write_b32 a44, v56
    v_accvgpr_write_b32 a45, v57
    v_accvgpr_write_b32 a46, v58
    v_accvgpr_write_b32 a47, v59
    s_branch L_conv3_back
L_conv3_6:
    ds_read_b128 v[172:175], v5 offset:0
    ds_read_b128 v[176:179], v5 offset:2048
    ds_read_b128 v[180:183], v5 offset:4096
    ds_read_b128 v[184:187], v5 offset:6144
    ds_read_b128 v[188:191], v5 offset:1024
    ds_read_b128 v[192:195], v5 offset:3072
    ds_read_b128 v[196:199], v5 offset:5120
    ds_read_b128 v[200:203], v5 offset:7168
    s_waitcnt lgkmcnt(0)
    v_perm_b32 v52, v176, v172, s48
    v_perm_b32 v53, v184, v180, s48
    v_perm_b32 v54, v192, v188, s48
    v_perm_b32 v55, v200, v196, s48
    v_accvgpr_write_b32 a64, v52
    v_accvgpr_write_b32 a65, v53
    v_accvgpr_write_b32 a66, v54
    v_accvgpr_write_b32 a67, v55
    v_perm_b32 v56, v176, v172, s49
    v_perm_b32 v57, v184, v180, s49
    v_perm_b32 v58, v192, v188, s49
    v_perm_b32 v59, v200, v196, s49
    v_accvgpr_write_b32 a68, v56
    v_accvgpr_write_b32 a69, v57
    v_accvgpr_write_b32 a70, v58
    v_accvgpr_write_b32 a71, v59
    v_perm_b32 v52, v177, v173, s48
    v_perm_b32 v53, v185, v181, s48
    v_perm_b32 v54, v193, v189, s48
    v_perm_b32 v55, v201, v197, s48
    v_accvgpr_write_b32 a72, v52
    v_accvgpr_write_b32 a73, v53
    v_accvgpr_write_b32 a74, v54
    v_accvgpr_write_b32 a75, v55
    v_perm_b32 v56, v177, v173, s49
    v_perm_b32 v57, v185, v181, s49
    v_perm_b32 v58, v193, v189, s49
    v_perm_b32 v59, v201, v197, s49
    v_accvgpr_write_b32 a76, v56
    v_accvgpr_write_b32 a77, v57
    v_accvgpr_write_b32 a78, v58
    v_accvgpr_write_b32 a79, v59
    s_branch L_conv3_back
L_conv3_8:
    ds_read_b128 v[172:175], v5 offset:8192
    ds_read_b128 v[176:179], v5 offset:10240
    ds_read_b128 v[180:183], v5 offset:12288
    ds_read_b128 v[184:187], v5 offset:14336
    ds_read_b128 v[188:191], v5 offset:9216
    ds_read_b128 v[192:195], v5 offset:11264
    ds_read_b128 v[196:199], v5 offset:13312
    ds_read_b128 v[200:203], v5 offset:15360
    s_waitcnt lgkmcnt(0)
    v_perm_b32 v52, v176, v172, s48
    v_perm_b32 v53, v184, v180, s48
    v_perm_b32 v54, v192, v188, s48
    v_perm_b32 v55, v200, v196, s48
    v_accvgpr_write_b32 a96, v52
    v_accvgpr_write_b32 a97, v53
    v_accvgpr_write_b32 a98, v54
    v_accvgpr_write_b32 a99, v55
    v_perm_b32 v56, v176, v172, s49
    v_perm_b32 v57, v184, v180, s49
    v_perm_b32 v58, v192, v188, s49
    v_perm_b32 v59, v200, v196, s49
    v_accvgpr_write_b32 a100, v56
    v_accvgpr_write_b32 a101, v57
    v_accvgpr_write_b32 a102, v58
    v_accvgpr_write_b32 a103, v59
    v_perm_b32 v52, v177, v173, s48
    v_perm_b32 v53, v185, v181, s48
    v_perm_b32 v54, v193, v189, s48
    v_perm_b32 v55, v201, v197, s48
    v_accvgpr_write_b32 a104, v52
    v_accvgpr_write_b32 a105, v53
    v_accvgpr_write_b32 a106, v54
    v_accvgpr_write_b32 a107, v55
    v_perm_b32 v56, v177, v173, s49
    v_perm_b32 v57, v185, v181, s49
    v_perm_b32 v58, v193, v189, s49
    v_perm_b32 v59, v201, v197, s49
    v_accvgpr_write_b32 a108, v56
    v_accvgpr_write_b32 a109, v57
    v_accvgpr_write_b32 a110, v58
    v_accvgpr_write_b32 a111, v59
    s_branch L_conv3_back
L_conv11:
    s_cmp_eq_u32 s53, 2
    s_cbranch_scc1 L_conv11_2
    s_cmp_eq_u32 s53, 4
    s_cbranch_scc1 L_conv11_4
    s_cmp_eq_u32 s53, 6
    s_cbranch_scc1 L_conv11_6
    s_cmp_eq_u32 s53, 8
    s_cbranch_scc1 L_conv11_8
    s_branch L_conv11_back
L_conv11_2:
    ds_read_b128 v[172:175], v5 offset:0
    ds_read_b128 v[176:179], v5 offset:2048
    ds_read_b128 v[180:183], v5 offset:4096
    ds_read_b128 v[184:187], v5 offset:6144
    ds_read_b128 v[188:191], v5 offset:1024
    ds_read_b128 v[192:195], v5 offset:3072
    ds_read_b128 v[196:199], v5 offset:5120
    ds_read_b128 v[200:203], v5 offset:7168
    s_waitcnt lgkmcnt(0)
    v_perm_b32 v52, v178, v174, s48
    v_perm_b32 v53, v186, v182, s48
    v_perm_b32 v54, v194, v190, s48
    v_perm_b32 v55, v202, v198, s48
    v_accvgpr_write_b32 a16, v52
    v_accvgpr_write_b32 a17, v53
    v_accvgpr_write_b32 a18, v54
    v_accvgpr_write_b32 a19, v55
    v_perm_b32 v56, v178, v174, s49
    v_perm_b32 v57, v186, v182, s49
    v_perm_b32 v58, v194, v190, s49
    v_perm_b32 v59, v202, v198, s49
    v_accvgpr_write_b32 a20, v56
    v_accvgpr_write_b32 a21, v57
    v_accvgpr_write_b32 a22, v58
    v_accvgpr_write_b32 a23, v59
    v_perm_b32 v52, v179, v175, s48
    v_perm_b32 v53, v187, v183, s48
    v_perm_b32 v54, v195, v191, s48
    v_perm_b32 v55, v203, v199, s48
    v_accvgpr_write_b32 a24, v52
    v_accvgpr_write_b32 a25, v53
    v_accvgpr_write_b32 a26, v54
    v_accvgpr_write_b32 a27, v55
    v_perm_b32 v56, v179, v175, s49
    v_perm_b32 v57, v187, v183, s49
    v_perm_b32 v58, v195, v191, s49
    v_perm_b32 v59, v203, v199, s49
    v_accvgpr_write_b32 a28, v56
    v_accvgpr_write_b32 a29, v57
    v_accvgpr_write_b32 a30, v58
    v_accvgpr_write_b32 a31, v59
    s_branch L_conv11_back
L_conv11_4:
    ds_read_b128 v[172:175], v5 offset:8192
    ds_read_b128 v[176:179], v5 offset:10240
    ds_read_b128 v[180:183], v5 offset:12288
    ds_read_b128 v[184:187], v5 offset:14336
    ds_read_b128 v[188:191], v5 offset:9216
    ds_read_b128 v[192:195], v5 offset:11264
    ds_read_b128 v[196:199], v5 offset:13312
    ds_read_b128 v[200:203], v5 offset:15360
    s_waitcnt lgkmcnt(0)
    v_perm_b32 v52, v178, v174, s48
    v_perm_b32 v53, v186, v182, s48
    v_perm_b32 v54, v194, v190, s48
    v_perm_b32 v55, v202, v198, s48
    v_accvgpr_write_b32 a48, v52
    v_accvgpr_write_b32 a49, v53
    v_accvgpr_write_b32 a50, v54
    v_accvgpr_write_b32 a51, v55
    v_perm_b32 v56, v178, v174, s49
    v_perm_b32 v57, v186, v182, s49
    v_perm_b32 v58, v194, v190, s49
    v_perm_b32 v59, v202, v198, s49
    v_accvgpr_write_b32 a52, v56
    v_accvgpr_write_b32 a53, v57
    v_accvgpr_write_b32 a54, v58
    v_accvgpr_write_b32 a55, v59
    v_perm_b32 v52, v179, v175, s48
    v_perm_b32 v53, v187, v183, s48
    v_perm_b32 v54, v195, v191, s48
    v_perm_b32 v55, v203, v199, s48
    v_accvgpr_write_b32 a56, v52
    v_accvgpr_write_b32 a57, v53
    v_accvgpr_write_b32 a58, v54
    v_accvgpr_write_b32 a59, v55
    v_perm_b32 v56, v179, v175, s49
    v_perm_b32 v57, v187, v183, s49
    v_perm_b32 v58, v195, v191, s49
    v_perm_b32 v59, v203, v199, s49
    v_accvgpr_write_b32 a60, v56
    v_accvgpr_write_b32 a61, v57
    v_accvgpr_write_b32 a62, v58
    v_accvgpr_write_b32 a63, v59
    s_branch L_conv11_back
L_conv11_6:
    ds_read_b128 v[172:175], v5 offset:0
    ds_read_b128 v[176:179], v5 offset:2048
    ds_read_b128 v[180:183], v5 offset:4096
    ds_read_b128 v[184:187], v5 offset:6144
    ds_read_b128 v[188:191], v5 offset:1024
    ds_read_b128 v[192:195], v5 offset:3072
    ds_read_b128 v[196:199], v5 offset:5120
    ds_read_b128 v[200:203], v5 offset:7168
    s_waitcnt lgkmcnt(0)
    v_perm_b32 v52, v178, v174, s48
    v_perm_b32 v53, v186, v182, s48
    v_perm_b32 v54, v194, v190, s48
    v_perm_b32 v55, v202, v198, s48
    v_accvgpr_write_b32 a80, v52
    v_accvgpr_write_b32 a81, v53
    v_accvgpr_write_b32 a82, v54
    v_accvgpr_write_b32 a83, v55
    v_perm_b32 v56, v178, v174, s49
    v_perm_b32 v57, v186, v182, s49
    v_perm_b32 v58, v194, v190, s49
    v_perm_b32 v59, v202, v198, s49
    v_accvgpr_write_b32 a84, v56
    v_accvgpr_write_b32 a85, v57
    v_accvgpr_write_b32 a86, v58
    v_accvgpr_write_b32 a87, v59
    v_perm_b32 v52, v179, v175, s48
    v_perm_b32 v53, v187, v183, s48
    v_perm_b32 v54, v195, v191, s48
    v_perm_b32 v55, v203, v199, s48
    v_accvgpr_write_b32 a88, v52
    v_accvgpr_write_b32 a89, v53
    v_accvgpr_write_b32 a90, v54
    v_accvgpr_write_b32 a91, v55
    v_perm_b32 v56, v179, v175, s49
    v_perm_b32 v57, v187, v183, s49
    v_perm_b32 v58, v195, v191, s49
    v_perm_b32 v59, v203, v199, s49
    v_accvgpr_write_b32 a92, v56
    v_accvgpr_write_b32 a93, v57
    v_accvgpr_write_b32 a94, v58
    v_accvgpr_write_b32 a95, v59
    s_branch L_conv11_back
L_conv11_8:
    ds_read_b128 v[172:175], v5 offset:8192
    ds_read_b128 v[176:179], v5 offset:10240
    ds_read_b128 v[180:183], v5 offset:12288
    ds_read_b128 v[184:187], v5 offset:14336
    ds_read_b128 v[188:191], v5 offset:9216
    ds_read_b128 v[192:195], v5 offset:11264
    ds_read_b128 v[196:199], v5 offset:13312
    ds_read_b128 v[200:203], v5 offset:15360
    s_waitcnt lgkmcnt(0)
    v_perm_b32 v52, v178, v174, s48
    v_perm_b32 v53, v186, v182, s48
    v_perm_b32 v54, v194, v190, s48
    v_perm_b32 v55, v202, v198, s48
    v_accvgpr_write_b32 a112, v52
    v_accvgpr_write_b32 a113, v53
    v_accvgpr_write_b32 a114, v54
    v_accvgpr_write_b32 a115, v55
    v_perm_b32 v56, v178, v174, s49
    v_perm_b32 v57, v186, v182, s49
    v_perm_b32 v58, v194, v190, s49
    v_perm_b32 v59, v202, v198, s49
    v_accvgpr_write_b32 a116, v56
    v_accvgpr_write_b32 a117, v57
    v_accvgpr_write_b32 a118, v58
    v_accvgpr_write_b32 a119, v59
    v_perm_b32 v52, v179, v175, s48
    v_perm_b32 v53, v187, v183, s48
    v_perm_b32 v54, v195, v191, s48
    v_perm_b32 v55, v203, v199, s48
    v_accvgpr_write_b32 a120, v52
    v_accvgpr_write_b32 a121, v53
    v_accvgpr_write_b32 a122, v54
    v_accvgpr_write_b32 a123, v55
    v_perm_b32 v56, v179, v175, s49
    v_perm_b32 v57, v187, v183, s49
    v_perm_b32 v58, v195, v191, s49
    v_perm_b32 v59, v203, v199, s49
    v_accvgpr_write_b32 a124, v56
    v_accvgpr_write_b32 a125, v57
    v_accvgpr_write_b32 a126, v58
    v_accvgpr_write_b32 a127, v59
    s_branch L_conv11_back
.globl mha_reduce_kernel
.p2align 8
.type mha_reduce_kernel,@function
mha_reduce_kernel:
    s_cmp_ge_u32 s2, 128
    s_cbranch_scc1 L_red_end
    s_load_dwordx2 s[4:5], s[0:1], 40
    s_load_dwordx2 s[6:7], s[0:1], 56
    v_lshrrev_b32 v2, 6, v0
    s_mul_i32 s8, s2, 8
    v_add_u32 v2, s8, v2
    v_and_b32 v1, 7, v0
    v_bfe_u32 v3, v0, 3, 3
    v_lshrrev_b32 v4, 7, v2
    v_and_b32 v5, 127, v2
    v_lshlrev_b32 v6, 19, v4
    v_lshl_add_u32 v6, v3, 14, v6
    v_lshl_add_u32 v6, v5, 7, v6
    v_lshl_add_u32 v6, v1, 4, v6
    s_mov_b32 s14, 0x400000
    s_mov_b32 s15, 0x20000
    s_mov_b32 s16, 0x20000
    s_mov_b32 s17, 0x40000
    s_mov_b32 s18, 0x60000
    s_waitcnt lgkmcnt(0)
    s_mov_b32 s12, s6
    s_mov_b32 s13, s7
    buffer_load_dwordx4 v[8:11], v6, s[12:15], 0 offen
    buffer_load_dwordx4 v[12:15], v6, s[12:15], s16 offen
    buffer_load_dwordx4 v[16:19], v6, s[12:15], s17 offen
    buffer_load_dwordx4 v[20:23], v6, s[12:15], s18 offen
    s_mov_b32 s20, s4
    s_mov_b32 s21, s5
    s_mov_b32 s22, 0x10000
    s_mov_b32 s23, 0x20000
    v_lshlrev_b32 v7, 13, v4
    v_lshl_add_u32 v7, v1, 10, v7
    v_lshrrev_b32 v24, 3, v5
    v_lshl_add_u32 v7, v24, 6, v7
    v_and_b32 v24, 7, v5
    v_lshl_add_u32 v7, v24, 1, v7
    v_lshrrev_b32 v24, 1, v3
    v_lshl_add_u32 v7, v24, 4, v7
    s_waitcnt vmcnt(2)
    v_add_f32 v8, v8, v12
    v_add_f32 v9, v9, v13
    v_add_f32 v10, v10, v14
    v_add_f32 v11, v11, v15
    s_waitcnt vmcnt(0)
    v_add_f32 v16, v16, v20
    v_add_f32 v17, v17, v21
    v_add_f32 v18, v18, v22
    v_add_f32 v19, v19, v23
    v_add_f32 v8, v8, v16
    v_add_f32 v9, v9, v17
    v_add_f32 v10, v10, v18
    v_add_f32 v11, v11, v19
    s_nop 0
    v_permlane32_swap_b32 v8, v10
    v_permlane32_swap_b32 v9, v11
    v_add_f32 v8, v8, v10
    v_add_f32 v9, v9, v11
    s_nop 1
    v_permlane16_swap_b32 v8, v9
    v_add_f32 v8, v8, v9
    s_nop 1
    v_add_f32_dpp v8, v8, v8 row_ror:8 row_mask:0xf bank_mask:0xf
    v_cvt_pk_bf16_f32 v8, v8, v8
    s_mov_b32 exec_lo, 0x00ff00ff
    s_mov_b32 exec_hi, 0x00ff00ff
    buffer_store_short v8, v7, s[20:23], 0 offen
L_red_end:
    s_endpgm
.section .rodata,"a"
.p2align 6
.amdhsa_kernel standalone__mha_block_cached__sampling_kernel
  .amdhsa_next_free_vgpr 440
  .amdhsa_next_free_sgpr 100
  .amdhsa_accum_offset 216
  .amdhsa_group_segment_fixed_size 0
  .amdhsa_kernarg_size 64
  .amdhsa_user_sgpr_count 2
  .amdhsa_user_sgpr_kernarg_segment_ptr 1
  .amdhsa_system_sgpr_workgroup_id_x 1
  .amdhsa_float_denorm_mode_32 3
.end_amdhsa_kernel
.p2align 6
.amdhsa_kernel mha_reduce_kernel
  .amdhsa_next_free_vgpr 40
  .amdhsa_next_free_sgpr 32
  .amdhsa_accum_offset 40
  .amdhsa_group_segment_fixed_size 0
  .amdhsa_kernarg_size 64
  .amdhsa_user_sgpr_count 2
  .amdhsa_user_sgpr_kernarg_segment_ptr 1
  .amdhsa_system_sgpr_workgroup_id_x 1
  .amdhsa_float_denorm_mode_32 3
.end_amdhsa_kernel
```
